```python
import torch

def _softmax(x, axis=-1):
    return torch.softmax(x, dim=axis)
def _gelu(x):
    return torch.nn.functional.gelu(x, approximate="tanh")
def _silu(x):
    return torch.nn.functional.silu(x)
def _sigmoid(x):
    return torch.sigmoid(x)
def _layernorm(x, axis=-1, eps=1e-5):
    m = x.mean(dim=axis, keepdim=True)
    v = x.var(dim=axis, keepdim=True, unbiased=False)
    return (x - m) / torch.sqrt(v + eps)
def _scatter_add(tgt, idx, src, axis=0):
    return tgt.clone().index_add_(axis, idx, src)
def _segment_sum(src, seg, n):
    out = torch.zeros((n,) + src.shape[1:], dtype=src.dtype)
    return out.index_add_(0, seg, src)
def _pad(x, pw):
    flat = tuple(v for pair in reversed(pw) for v in pair)
    return torch.nn.functional.pad(x, flat)

kernel_name = 'parallel_sum__mha_block_cached__geglu_ffn__decode'

def setup_inputs():

    _w = (lambda a: (lambda t: t.to(torch.bfloat16) if t.is_floating_point() else t)(torch.as_tensor(a)))
    def _A_setup():
        B, Sq, D = 4, 1, 448
        H, Sk, Dh = 16, 4096, 256
        return {
            "x": _w((lambda *s: torch.randn(*s, dtype=torch.bfloat16) * 0.05)(B, Sq, D)),
            "k_cache": _w((lambda *s: torch.randn(*s, dtype=torch.bfloat16) * 3.2)(B, H, Sk, Dh)),
            "v_cache": _w((lambda *s: torch.randn(*s, dtype=torch.bfloat16) * 1.6)(B, H, Sk, Dh)),
            "wq": _w((lambda *s: torch.randn(*s, dtype=torch.bfloat16) * 3.2)(D, H * Dh) * (D ** -0.5)),
            "wo": _w((lambda *s: torch.randn(*s, dtype=torch.bfloat16) * 1.6)(H * Dh, D) * ((H * Dh) ** -0.5)),
        }
    _A_in = _A_setup()

    def _B_setup():
        B, S, D, F = 4, 1, 448, 1792
        return {
            "x": _w((lambda *s: torch.randn(*s, dtype=torch.bfloat16) * 0.05)(B, S, D)),
            "w_gate": _w((lambda *s: torch.randn(*s, dtype=torch.bfloat16) * 0.05)(D, F)),
            "w_up": _w((lambda *s: torch.randn(*s, dtype=torch.bfloat16) * 0.05)(D, F)),
            "w_down": _w((lambda *s: torch.randn(*s, dtype=torch.bfloat16) * 0.05)(F, D)),
        }
    _B_in = _B_setup()

    return {
        "A_x": _A_in["x"],
        "A_k_cache": _A_in["k_cache"],
        "A_v_cache": _A_in["v_cache"],
        "A_wq": _A_in["wq"],
        "A_wo": _A_in["wo"],
        "B_x": _B_in["x"],
        "B_w_gate": _B_in["w_gate"],
        "B_w_up": _B_in["w_up"],
        "B_w_down": _B_in["w_down"],
    }

def reference(A_x, A_k_cache, A_v_cache, A_wq, A_wo, B_x, B_w_gate, B_w_up, B_w_down):
    def _A_ref(x, k_cache, v_cache, wq, wo):
        B, Sq, D = x.shape
        H, Dh = 16, 256
        q = (lambda x, *d: x.permute(*d))((x @ wq).reshape(B, Sq, H, Dh), 0, 2, 1, 3)
        scores = torch.einsum("bhqd,bhkd->bhqk", q, k_cache) * (Dh ** -0.5)
        p = _softmax(scores, axis=-1)
        o = torch.einsum("bhqk,bhkd->bhqd", p, v_cache)
        return (lambda x, *d: x.permute(*d))(o, 0, 2, 1, 3).reshape(B, Sq, H * Dh) @ wo

    def _B_ref(x, w_gate, w_up, w_down):
        return (_gelu(x @ w_gate) * (x @ w_up)) @ w_down

    x = A_x
    xn = _layernorm(x, axis=-1)
    return x + _A_ref(xn, A_k_cache, A_v_cache, A_wq, A_wo) + _B_ref(xn, B_w_gate, B_w_up, B_w_down)
```

```asm
; @launch grid=(256,1,1) block=(320,1,1) lds=65536
.amdgcn_target "amdgcn-amd-amdhsa--gfx950"
.text
.globl parallel_sum__mha_block_cached__geglu_ffn__decode_kernel
.p2align 8
.type parallel_sum__mha_block_cached__geglu_ffn__decode_kernel,@function
parallel_sum__mha_block_cached__geglu_ffn__decode_kernel:
    s_load_dwordx2 s[28:29], s[0:1], 8
    v_lshrrev_b32 v1, 6, v0
    s_cmpk_ge_u32 s2, 256
    s_cbranch_scc1 L_end
    v_readfirstlane_b32 s3, v1
    v_and_b32 v85, 51, v0
    v_and_b32 v1, 12, v0
    s_cmp_eq_u32 s3, 0
    s_cbranch_scc1 L_helper
    v_mul_u32_u24 v85, 20, v85
    v_mul_u32_u24 v1, 0x2400, v1
    v_and_b32 v85, 0xf0, v85
    v_and_b32 v1, 0xa000, v1
    v_or_b32 v1, v1, v85
    s_lshr_b32 s65, s2, 6
    s_mulk_i32 s65, 9
    s_and_b32 s65, s65, 17
    s_lshl_b32 s65, s65, 12
    s_mul_i32 s66, s3, 5
    s_and_b32 s66, s66, 9
    s_lshl_b32 s66, s66, 11
    s_and_b32 s63, s2, 63
    s_lshl_b32 s63, s63, 21
    s_or_b32 s65, s65, s66
    s_or_b32 s63, s63, s65
    s_lshl_b32 s30, 1, 27
    s_mov_b32 s31, 0x20000
    s_waitcnt lgkmcnt(0)
    buffer_load_dwordx4 v[96:99], v1, s[28:31], s63 offen nt
    buffer_load_dwordx4 v[100:103], v1, s[28:31], s63 offen offset:256 nt
    buffer_load_dwordx4 v[104:107], v1, s[28:31], s63 offen offset:512 nt
    buffer_load_dwordx4 v[108:111], v1, s[28:31], s63 offen offset:768 nt
    buffer_load_dwordx4 v[112:115], v1, s[28:31], s63 offen offset:1024 nt
    s_load_dwordx16 s[4:19], s[0:1], 0
    s_load_dwordx8 s[20:27], s[0:1], 64
    s_mov_b32 s64, s63
    s_and_b32 s72, s3, 3
    s_and_b32 s60, s2, 63
    s_lshr_b32 s58, s2, 6
    s_lshr_b32 s56, s60, 4
    s_and_b32 s57, s2, 15
    s_lshl_b32 s2, s60, 2
    s_or_b32 s2, s2, s58
    s_and_b32 s59, s2, 63
    s_lshl_b32 s73, s57, 1
    s_and_b32 s65, s58, 1
    s_or_b32 s73, s73, s65
    s_lshl_b32 s79, s56, 1
    s_lshr_b32 s65, s58, 1
    s_or_b32 s79, s79, s65
    v_and_b32 v0, 63, v0
    v_and_b32 v4, 15, v0
    v_lshrrev_b32 v5, 4, v0
    s_and_b32 s65, s2, 0xe2
    s_lshl_b32 s65, s65, 2
    s_or_b32 s65, s65, s72
    s_cbranch_scc1 L_nowarm2
    s_getpc_b64 s[66:67]
L_pc:
    v_lshlrev_b32 v2, 7, v0
    global_load_dword v31, v2, s[66:67]
    v_add_u32 v2, 0x2000, v2
    v_min_u32 v2, L_end-L_pc, v2
    global_load_dword v31, v2, s[66:67]
L_nowarm2:
    s_waitcnt vmcnt(4)
    buffer_load_dwordx4 v[116:119], v1, s[28:31], s63 offen offset:1280 nt
    s_waitcnt vmcnt(4)
    buffer_load_dwordx4 v[120:123], v1, s[28:31], s63 offen offset:1536 nt
    s_waitcnt vmcnt(4)
    buffer_load_dwordx4 v[124:127], v1, s[28:31], s63 offen offset:1792 nt
    s_add_u32 s63, s63, 0x20000
    s_waitcnt vmcnt(4)
    buffer_load_dwordx4 v[128:131], v1, s[28:31], s63 offen nt
    s_waitcnt vmcnt(4)
    buffer_load_dwordx4 v[132:135], v1, s[28:31], s63 offen offset:256 nt
    s_waitcnt vmcnt(4)
    buffer_load_dwordx4 v[136:139], v1, s[28:31], s63 offen offset:512 nt
    s_waitcnt vmcnt(4)
    buffer_load_dwordx4 v[140:143], v1, s[28:31], s63 offen offset:768 nt
    s_waitcnt vmcnt(4)
    buffer_load_dwordx4 v[144:147], v1, s[28:31], s63 offen offset:1024 nt
    s_waitcnt vmcnt(4)
    buffer_load_dwordx4 v[148:151], v1, s[28:31], s63 offen offset:1280 nt
    s_waitcnt vmcnt(4)
    buffer_load_dwordx4 v[152:155], v1, s[28:31], s63 offen offset:1536 nt
    s_waitcnt vmcnt(4)
    buffer_load_dwordx4 v[156:159], v1, s[28:31], s63 offen offset:1792 nt
    s_add_u32 s63, s63, 0x20000
    s_waitcnt vmcnt(4)
    buffer_load_dwordx4 v[160:163], v1, s[28:31], s63 offen nt
    s_waitcnt lgkmcnt(0)
    v_lshlrev_b32 v2, 4, v4
    v_bfe_u32 v84, v0, 4, 1
    v_lshl_add_u32 v2, v84, 15, v2
    v_bfe_u32 v84, v0, 5, 1
    v_lshl_add_u32 v2, v84, 13, v2
    s_mov_b32 s32, s8
    s_mov_b32 s33, s9
    s_mov_b32 s34, 134217728
    s_mov_b32 s35, 0x20000
    s_waitcnt vmcnt(4)
    buffer_load_dwordx4 v[164:167], v1, s[28:31], s63 offen offset:256 nt
    s_mov_b32 s36, s26
    s_mov_b32 s37, s27
    s_mov_b32 s38, 4259840
    s_mov_b32 s39, 0x20000
    s_mov_b32 s48, s22
    s_mov_b32 s49, s23
    s_mov_b32 s50, 3584
    s_mov_b32 s51, 0x20000
    s_waitcnt vmcnt(4)
    buffer_load_dwordx4 v[168:171], v1, s[28:31], s63 offen offset:512 nt
    s_mov_b32 s52, s4
    s_mov_b32 s53, s5
    s_mov_b32 s54, 3584
    s_mov_b32 s55, 0x20000
    s_mov_b32 s40, s12
    s_mov_b32 s41, s13
    s_mov_b32 s42, 3670016
    s_mov_b32 s43, 0x20000
    s_waitcnt vmcnt(4)
    buffer_load_dwordx4 v[172:175], v1, s[28:31], s63 offen offset:768 nt
    s_mov_b32 s44, s20
    s_mov_b32 s45, s21
    s_mov_b32 s46, 1605632
    s_mov_b32 s47, 0x20000
    v_mov_b32 v32, 0
    v_mov_b32 v33, 0
    s_waitcnt vmcnt(4)
    buffer_load_dwordx4 v[176:179], v1, s[28:31], s63 offen offset:1024 nt
    v_mov_b32 v34, 0
    v_mov_b32 v35, 0
    v_mov_b32 v36, 0
    v_mov_b32 v37, 0
    v_mov_b32 v38, 0
    v_mov_b32 v39, 0
    s_waitcnt vmcnt(4)
    buffer_load_dwordx4 v[180:183], v1, s[28:31], s63 offen offset:1280 nt
    v_mov_b32 v40, 0
    v_mov_b32 v41, 0
    v_mov_b32 v42, 0
    v_mov_b32 v43, 0
    v_mov_b32 v44, 0
    v_mov_b32 v45, 0
    s_waitcnt vmcnt(4)
    buffer_load_dwordx4 v[184:187], v1, s[28:31], s63 offen offset:1536 nt
    v_mov_b32 v46, 0
    v_mov_b32 v47, 0
    v_mov_b32 v48, 0
    v_mov_b32 v49, 0
    v_mov_b32 v50, 0
    v_mov_b32 v51, 0
    s_waitcnt vmcnt(4)
    buffer_load_dwordx4 v[188:191], v1, s[28:31], s63 offen offset:1792 nt
    s_add_u32 s63, s63, 0x20000
    v_mov_b32 v52, 0
    v_mov_b32 v53, 0
    v_mov_b32 v54, 0
    v_mov_b32 v55, 0
    v_mov_b32 v56, 0
    v_mov_b32 v57, 0
    s_waitcnt vmcnt(4)
    buffer_load_dwordx4 v[192:195], v1, s[28:31], s63 offen nt
    v_mov_b32 v58, 0
    v_mov_b32 v59, 0
    v_mov_b32 v60, 0
    v_mov_b32 v61, 0
    v_mov_b32 v62, 0
    v_mov_b32 v63, 0
    s_waitcnt vmcnt(4)
    buffer_load_dwordx4 v[196:199], v1, s[28:31], s63 offen offset:256 nt
    v_mov_b32 v12, 0
    v_mov_b32 v13, 0
    v_mov_b32 v14, 0
    v_mov_b32 v15, 0
    v_mov_b32 v16, 0
    v_mov_b32 v17, 0
    s_waitcnt vmcnt(4)
    buffer_load_dwordx4 v[200:203], v1, s[28:31], s63 offen offset:512 nt
    v_mov_b32 v18, 0
    v_mov_b32 v19, 0
    v_mov_b32 v6, 0xff800000
    v_mov_b32 v7, 0
    v_mov_b32 v28, 0x3db8aa3b
    v_and_b32 v88, 1, v4
    v_lshlrev_b32 v88, 4, v88
    v_mov_b32 v89, 0xffff
    v_lshlrev_b32 v88, v88, v89
    s_waitcnt vmcnt(4)
    buffer_load_dwordx4 v[204:207], v1, s[28:31], s63 offen offset:768 nt
    v_bfe_u32 v89, v4, 1, 2
    v_cmp_eq_u32 vcc, 0, v89
    s_nop 1
    v_cndmask_b32 v8, 0, v88, vcc
    v_cmp_eq_u32 vcc, 1, v89
    s_nop 1
    v_cndmask_b32 v9, 0, v88, vcc
    v_cmp_eq_u32 vcc, 2, v89
    s_nop 1
    v_cndmask_b32 v10, 0, v88, vcc
    s_waitcnt vmcnt(4)
    buffer_load_dwordx4 v[208:211], v1, s[28:31], s63 offen offset:1024 nt
    v_cmp_eq_u32 vcc, 3, v89
    s_nop 1
    v_cndmask_b32 v11, 0, v88, vcc
    s_lshl_b32 s65, s72, 12
    s_add_u32 s65, s65, 10240
    v_lshl_add_u32 v3, v0, 2, s65
    s_waitcnt vmcnt(4)
    buffer_load_dwordx4 v[212:215], v1, s[28:31], s63 offen offset:1280 nt
    s_waitcnt vmcnt(4)
    buffer_load_dwordx4 v[216:219], v1, s[28:31], s63 offen offset:1536 nt
    s_waitcnt vmcnt(4)
    buffer_load_dwordx4 v[220:223], v1, s[28:31], s63 offen offset:1792 nt
    s_add_u32 s63, s63, 0x20000
    s_waitcnt vmcnt(4)
    buffer_load_dwordx4 v[224:227], v1, s[28:31], s63 offen nt
    s_waitcnt vmcnt(4)
    buffer_load_dwordx4 v[228:231], v1, s[28:31], s63 offen offset:256 nt
    s_waitcnt vmcnt(4)
    buffer_load_dwordx4 v[232:235], v1, s[28:31], s63 offen offset:512 nt
    s_waitcnt vmcnt(4)
    buffer_load_dwordx4 v[236:239], v1, s[28:31], s63 offen offset:768 nt
    s_waitcnt vmcnt(4)
    buffer_load_dwordx4 v[240:243], v1, s[28:31], s63 offen offset:1024 nt
    s_waitcnt vmcnt(4)
    buffer_load_dwordx4 v[244:247], v1, s[28:31], s63 offen offset:1280 nt
    s_waitcnt vmcnt(4)
    buffer_load_dwordx4 v[248:251], v1, s[28:31], s63 offen offset:1536 nt
    s_waitcnt vmcnt(4)
    buffer_load_dwordx4 v[252:255], v1, s[28:31], s63 offen offset:1792 nt
    s_add_u32 s63, s63, 0x20000
    s_barrier
    s_mov_b32 exec_lo, 0xf000f
    s_mov_b32 exec_hi, 0xf000f
    ds_read_b128 v[32:35], v85 offset:3584
    ds_read_b128 v[36:39], v85 offset:3840
    s_mov_b32 exec_lo, 0xf000f0
    s_mov_b32 exec_hi, 0xf000f0
    ds_read_b128 v[40:43], v85 offset:3584
    ds_read_b128 v[44:47], v85 offset:3840
    s_mov_b32 exec_lo, 0xf000f00
    s_mov_b32 exec_hi, 0xf000f00
    ds_read_b128 v[48:51], v85 offset:3584
    ds_read_b128 v[52:55], v85 offset:3840
    s_mov_b32 exec_lo, 0xf000f000
    s_mov_b32 exec_hi, 0xf000f000
    ds_read_b128 v[56:59], v85 offset:3584
    ds_read_b128 v[60:63], v85 offset:3840
    s_mov_b64 exec, -1
    v_mov_b32 v84, 0
    ds_read_b64 v[86:87], v84 offset:4096
    s_waitcnt lgkmcnt(0)
    v_readfirstlane_b32 s61, v86
    v_readfirstlane_b32 s101, v87
    v_mfma_f32_16x16x32_bf16 v[64:67], v[96:99], v[32:35], 0
    s_waitcnt vmcnt(4)
    buffer_load_dwordx4 v[96:99], v1, s[28:31], s63 offen nt
    v_mfma_f32_16x16x32_bf16 v[68:71], v[128:131], v[32:35], 0
    v_mfma_f32_16x16x32_bf16 v[72:75], v[160:163], v[32:35], 0
    v_mfma_f32_16x16x32_bf16 v[76:79], v[192:195], v[32:35], 0
    v_mfma_f32_16x16x32_bf16 v[80:83], v[224:227], v[32:35], 0
    v_mfma_f32_16x16x32_bf16 v[64:67], v[100:103], v[36:39], v[64:67]
    s_waitcnt vmcnt(4)
    buffer_load_dwordx4 v[100:103], v1, s[28:31], s63 offen offset:256 nt
    v_mfma_f32_16x16x32_bf16 v[68:71], v[132:135], v[36:39], v[68:71]
    v_mfma_f32_16x16x32_bf16 v[72:75], v[164:167], v[36:39], v[72:75]
    v_mfma_f32_16x16x32_bf16 v[76:79], v[196:199], v[36:39], v[76:79]
    v_mfma_f32_16x16x32_bf16 v[80:83], v[228:231], v[36:39], v[80:83]
    v_mfma_f32_16x16x32_bf16 v[64:67], v[104:107], v[40:43], v[64:67]
    s_waitcnt vmcnt(4)
    buffer_load_dwordx4 v[104:107], v1, s[28:31], s63 offen offset:512 nt
    v_mfma_f32_16x16x32_bf16 v[68:71], v[136:139], v[40:43], v[68:71]
    v_mfma_f32_16x16x32_bf16 v[72:75], v[168:171], v[40:43], v[72:75]
    v_mfma_f32_16x16x32_bf16 v[76:79], v[200:203], v[40:43], v[76:79]
    v_mfma_f32_16x16x32_bf16 v[80:83], v[232:235], v[40:43], v[80:83]
    v_mfma_f32_16x16x32_bf16 v[64:67], v[108:111], v[44:47], v[64:67]
    s_waitcnt vmcnt(4)
    buffer_load_dwordx4 v[108:111], v1, s[28:31], s63 offen offset:768 nt
    v_mfma_f32_16x16x32_bf16 v[68:71], v[140:143], v[44:47], v[68:71]
    v_mfma_f32_16x16x32_bf16 v[72:75], v[172:175], v[44:47], v[72:75]
    v_mfma_f32_16x16x32_bf16 v[76:79], v[204:207], v[44:47], v[76:79]
    v_mfma_f32_16x16x32_bf16 v[80:83], v[236:239], v[44:47], v[80:83]
    v_mfma_f32_16x16x32_bf16 v[64:67], v[112:115], v[48:51], v[64:67]
    s_waitcnt vmcnt(4)
    buffer_load_dwordx4 v[112:115], v1, s[28:31], s63 offen offset:1024 nt
    v_mfma_f32_16x16x32_bf16 v[68:71], v[144:147], v[48:51], v[68:71]
    v_mfma_f32_16x16x32_bf16 v[72:75], v[176:179], v[48:51], v[72:75]
    v_mfma_f32_16x16x32_bf16 v[76:79], v[208:211], v[48:51], v[76:79]
    v_mfma_f32_16x16x32_bf16 v[80:83], v[240:243], v[48:51], v[80:83]
    v_mfma_f32_16x16x32_bf16 v[64:67], v[116:119], v[52:55], v[64:67]
    s_waitcnt vmcnt(4)
    buffer_load_dwordx4 v[116:119], v1, s[28:31], s63 offen offset:1280 nt
    v_mfma_f32_16x16x32_bf16 v[68:71], v[148:151], v[52:55], v[68:71]
    v_mfma_f32_16x16x32_bf16 v[72:75], v[180:183], v[52:55], v[72:75]
    v_mfma_f32_16x16x32_bf16 v[76:79], v[212:215], v[52:55], v[76:79]
    v_mfma_f32_16x16x32_bf16 v[80:83], v[244:247], v[52:55], v[80:83]
    v_mfma_f32_16x16x32_bf16 v[64:67], v[120:123], v[56:59], v[64:67]
    s_waitcnt vmcnt(4)
    buffer_load_dwordx4 v[120:123], v1, s[28:31], s63 offen offset:1536 nt
    v_mfma_f32_16x16x32_bf16 v[68:71], v[152:155], v[56:59], v[68:71]
    v_mfma_f32_16x16x32_bf16 v[72:75], v[184:187], v[56:59], v[72:75]
    v_mfma_f32_16x16x32_bf16 v[76:79], v[216:219], v[56:59], v[76:79]
    v_mfma_f32_16x16x32_bf16 v[80:83], v[248:251], v[56:59], v[80:83]
    v_mfma_f32_16x16x32_bf16 v[64:67], v[124:127], v[60:63], v[64:67]
    s_waitcnt vmcnt(4)
    buffer_load_dwordx4 v[124:127], v1, s[28:31], s63 offen offset:1792 nt
    s_add_u32 s63, s63, 0x20000
    v_mfma_f32_16x16x32_bf16 v[68:71], v[156:159], v[60:63], v[68:71]
    v_mfma_f32_16x16x32_bf16 v[72:75], v[188:191], v[60:63], v[72:75]
    v_mfma_f32_16x16x32_bf16 v[76:79], v[220:223], v[60:63], v[76:79]
    v_mfma_f32_16x16x32_bf16 v[80:83], v[252:255], v[60:63], v[80:83]
    s_nop 0
    v_mov_b32_dpp v84, v64 quad_perm:[0,0,0,0] row_mask:0xf bank_mask:0xf
    s_nop 2
    v_mov_b32_dpp v85, v68 quad_perm:[0,0,0,0] row_mask:0xf bank_mask:0xf
    v_mov_b32_dpp v86, v72 quad_perm:[0,0,0,0] row_mask:0xf bank_mask:0xf
    v_mov_b32_dpp v87, v76 quad_perm:[0,0,0,0] row_mask:0xf bank_mask:0xf
    v_mov_b32_dpp v88, v80 quad_perm:[0,0,0,0] row_mask:0xf bank_mask:0xf
    v_add_f32_dpp v84, v65, v84 quad_perm:[1,1,1,1] row_mask:0xf bank_mask:0xf
    v_add_f32_dpp v85, v69, v85 quad_perm:[1,1,1,1] row_mask:0xf bank_mask:0xf
    v_add_f32_dpp v86, v73, v86 quad_perm:[1,1,1,1] row_mask:0xf bank_mask:0xf
    v_add_f32_dpp v87, v77, v87 quad_perm:[1,1,1,1] row_mask:0xf bank_mask:0xf
    v_add_f32_dpp v88, v81, v88 quad_perm:[1,1,1,1] row_mask:0xf bank_mask:0xf
    v_add_f32_dpp v84, v66, v84 quad_perm:[2,2,2,2] row_mask:0xf bank_mask:0xf
    v_add_f32_dpp v85, v70, v85 quad_perm:[2,2,2,2] row_mask:0xf bank_mask:0xf
    v_add_f32_dpp v86, v74, v86 quad_perm:[2,2,2,2] row_mask:0xf bank_mask:0xf
    v_add_f32_dpp v87, v78, v87 quad_perm:[2,2,2,2] row_mask:0xf bank_mask:0xf
    v_add_f32_dpp v88, v82, v88 quad_perm:[2,2,2,2] row_mask:0xf bank_mask:0xf
    v_add_f32_dpp v84, v67, v84 quad_perm:[3,3,3,3] row_mask:0xf bank_mask:0xf
    v_add_f32_dpp v85, v71, v85 quad_perm:[3,3,3,3] row_mask:0xf bank_mask:0xf
    v_add_f32_dpp v86, v75, v86 quad_perm:[3,3,3,3] row_mask:0xf bank_mask:0xf
    v_add_f32_dpp v87, v79, v87 quad_perm:[3,3,3,3] row_mask:0xf bank_mask:0xf
    v_add_f32_dpp v88, v83, v88 quad_perm:[3,3,3,3] row_mask:0xf bank_mask:0xf
    v_cvt_pk_bf16_f32 v84, v84, v84
    v_cvt_pk_bf16_f32 v85, v85, v85
    v_cvt_pk_bf16_f32 v86, v86, v86
    v_cvt_pk_bf16_f32 v87, v87, v87
    v_cvt_pk_bf16_f32 v88, v88, v88
    v_and_b32 v84, 0xffff0000, v84
    v_and_b32 v85, 0xffff0000, v85
    v_and_b32 v86, 0xffff0000, v86
    v_and_b32 v87, 0xffff0000, v87
    v_and_b32 v88, 0xffff0000, v88
    ds_write_b32 v3, v84 offset:0
    v_max_f32 v6, v6, v84
    ds_write_b32 v3, v85 offset:256
    v_max_f32 v6, v6, v85
    ds_write_b32 v3, v86 offset:512
    v_max_f32 v6, v6, v86
    ds_write_b32 v3, v87 offset:768
    v_max_f32 v6, v6, v87
    ds_write_b32 v3, v88 offset:1024
    v_max_f32 v6, v6, v88
    v_add_u32 v3, 1280, v3
    s_lshl_b32 s65, s72, 10
    s_add_u32 s65, s65, 6144
    v_lshl_add_u32 v130, v0, 4, s65
    s_lshl_b32 s65, s72, 3
    s_add_u32 s65, s65, 4128
    v_mov_b32 v131, s65
    s_lshl_b32 s65, s72, 8
    s_add_u32 s65, s65, 6144
    v_lshl_add_u32 v132, v0, 3, s65
    v_mov_b32 v133, 0
    v_lshlrev_b32 v134, 4, v0
    v_mov_b32 v167, s61
    s_lshl_b32 s70, s2, 11
    s_lshl_b32 s65, s72, 9
    s_add_u32 s70, s70, s65
    s_add_u32 s70, s70, 655360
    s_lshl_b32 s71, s72, 17
    s_lshr_b32 s65, s73, 1
    s_lshl_b32 s65, s65, 13
    s_add_u32 s71, s71, s65
    s_and_b32 s65, s73, 1
    s_lshl_b32 s65, s65, 10
    s_add_u32 s71, s71, s65
    s_add_u32 s71, s71, 655360
    s_add_u32 s74, s71, 4096
    v_lshrrev_b32 v236, 3, v0
    v_and_b32 v237, 7, v0
    v_and_b32 v238, 2, v236
    v_xor_b32 v237, v237, v238
    v_lshlrev_b32 v237, 4, v237
    v_and_b32 v238, 3, v236
    v_lshlrev_b32 v238, 3, v238
    v_lshrrev_b32 v239, 2, v236
    v_add_u32 v238, v238, v239
    v_mul_u32_u24 v143, 896, v238
    v_mul_u32_u24 v144, 896, v236
    s_and_b32 s65, s72, 1
    s_lshl_b32 s65, s65, 6
    v_xor_b32 v237, s65, v237
    v_add_u32 v143, v143, v237
    v_add_u32 v144, v144, v237
    s_lshr_b32 s66, s73, 1
    s_lshl_b32 s66, s66, 8
    s_and_b32 s65, s73, 1
    s_lshl_b32 s65, s65, 6
    s_add_u32 s66, s66, s65
    s_lshl_b32 s65, s72, 1
    s_add_u32 s66, s66, s65
    s_mul_i32 s66, s66, 896
    s_lshl_b32 s65, s79, 7
    s_add_u32 s66, s66, s65
    s_lshl_b32 s67, s73, 6
    s_lshl_b32 s68, s72, 3
    s_add_u32 s67, s67, s68
    s_mul_i32 s67, s67, 896
    s_add_u32 s67, s67, s65
    s_lshl_b32 s75, s72, 10
    v_lshrrev_b32 v236, 2, v4
    v_bfe_u32 v237, v4, 1, 1
    s_lshl_b32 s65, s72, 1
    v_add_u32 v237, s65, v237
    v_and_b32 v238, 2, v236
    v_xor_b32 v237, v237, v238
    v_and_b32 v239, 1, v4
    v_lshlrev_b32 v239, 3, v239
    v_lshl_add_u32 v239, v236, 7, v239
    v_and_b32 v238, 1, v5
    v_lshlrev_b32 v238, 2, v238
    v_xor_b32 v240, v237, v238
    v_lshl_add_u32 v136, v240, 4, v239
    v_lshl_add_u32 v136, v5, 10, v136
    v_mul_u32_u24 v140, 144, v236
    v_lshl_add_u32 v140, v5, 4, v140
    v_mul_u32_u24 v141, 272, v236
    v_lshl_add_u32 v141, v5, 4, v141
    s_mul_i32 s65, s72, 272
    s_add_u32 s65, s65, 4864
    v_lshl_add_u32 v142, v0, 2, s65
    v_lshlrev_b32 v135, 3, v4
    v_bfe_u32 v236, v0, 4, 1
    v_lshl_add_u32 v135, v236, 12, v135
    v_bfe_u32 v236, v0, 5, 1
    v_lshl_add_u32 v135, v236, 14, v135
    s_lshl_b32 s68, s79, 2
    s_add_u32 s68, s68, s72
    s_lshl_b32 s68, s68, 15
    s_lshl_b32 s65, s73, 7
    s_add_u32 s68, s68, s65
    s_add_u32 s68, s68, 1179648
    s_mov_b32 s100, s73
    s_and_b32 s78, s100, 0xfc
    s_add_u32 s78, s78, s72
    s_lshl_b32 s69, s78, 4
    s_lshl_b32 s78, s78, 3
    s_and_b32 s65, s100, 2
    s_add_u32 s78, s78, s65
    s_and_b32 s65, s100, 3
    s_add_u32 s78, s78, s65
    s_lshl_b32 s78, s78, 12
    s_add_u32 s78, s78, 1179648
    s_add_u32 s19, s68, 8192
    s_mul_i32 s65, s65, 448
    s_add_u32 s69, s69, s65
    s_lshl_b32 s69, s69, 1
    v_and_b32 v236, 7, v0
    v_and_b32 v237, 1, v5
    v_lshlrev_b32 v129, 2, v236
    v_lshl_add_u32 v129, v237, 1, v129
    s_add_u32 s65, s72, s58
    s_and_b32 s65, s65, 3
    s_lshl_b32 s13, s57, 2
    s_add_u32 s13, s13, s65
    s_lshl_b32 s13, s13, 7
    s_add_u32 s13, s13, 32768
    s_cmp_lg_u32 s101, 0
    s_cselect_b32 s13, 0x40000000, s13
    s_cselect_b32 s14, 8, 0
    s_cselect_b32 s16, 0, 16
    s_lshl_b32 s65, s56, 2
    s_add_u32 s65, s65, s58
    s_lshl_b32 s65, s65, 2
    s_add_u32 s12, s13, s65
    s_lshl_b32 s65, s72, 2
    s_add_u32 s65, s65, 4112
    v_mov_b32 v247, s65
    v_mov_b32 v244, 0
    v_bfe_i32 v245, v0, 0, 1
    v_lshlrev_b32 v246, 2, v0
    s_mov_b32 s62, 10
    s_nop 0
L_kk:
    v_readlane_b32 s15, v245, 16
    v_add_u32_dpp v245, v245, v245 row_ror:8 row_mask:0xf bank_mask:0xf
    s_nop 1
    v_add_u32_dpp v245, v245, v245 row_ror:4 row_mask:0xf bank_mask:0xf
    s_nop 1
    v_add_u32_dpp v245, v245, v245 row_ror:2 row_mask:0xf bank_mask:0xf
    s_nop 1
    v_add_u32_dpp v245, v245, v245 row_ror:1 row_mask:0xf bank_mask:0xf
    v_add_u32 v244, 1, v244
    v_readfirstlane_b32 s65, v245
    s_nop 0
    s_add_u32 s65, s65, s15
    s_mov_b64 exec, 1
    buffer_store_dword v244, v133, s[36:39], s12 offen
    ds_write_b32 v247, v244
    s_mov_b64 exec, 0x1ffff
    buffer_load_dword v245, v246, s[36:39], s13 offen sc1
    s_mov_b64 exec, -1
    s_sub_u32 s17, s65, s14
    s_add_u32 s14, s14, s16
    s_sub_u32 s65, s17, -15
    s_cmp_gt_u32 s65, 23
    s_cselect_b64 vcc, -1, 0
    s_cmp_gt_i32 s17, 0
    v_mfma_f32_16x16x32_bf16 v[64:67], v[96:99], v[32:35], 0
    s_cbranch_scc1 L_w1
    s_cbranch_vccz L_m1
    s_waitcnt vmcnt(5)
L_m1:
    s_waitcnt vmcnt(6)
L_w1:
    s_cbranch_vccnz L_x1
    s_waitcnt vmcnt(7)
L_x1:
    s_waitcnt vmcnt(8)
    buffer_load_dwordx4 v[96:99], v1, s[28:31], s63 offen nt
    v_mfma_f32_16x16x32_bf16 v[64:67], v[100:103], v[36:39], v[64:67]
    s_cbranch_scc1 L_w2
    s_cbranch_vccz L_m2
    s_waitcnt vmcnt(5)
L_m2:
    s_waitcnt vmcnt(6)
L_w2:
    s_cbranch_vccnz L_x2
    s_waitcnt vmcnt(7)
L_x2:
    s_waitcnt vmcnt(8)
    buffer_load_dwordx4 v[100:103], v1, s[28:31], s63 offen offset:256 nt
    v_mfma_f32_16x16x32_bf16 v[64:67], v[104:107], v[40:43], v[64:67]
    s_cbranch_scc1 L_w3
    s_cbranch_vccz L_m3
    s_waitcnt vmcnt(5)
L_m3:
    s_waitcnt vmcnt(6)
L_w3:
    s_cbranch_vccnz L_x3
    s_waitcnt vmcnt(7)
L_x3:
    s_waitcnt vmcnt(8)
    buffer_load_dwordx4 v[104:107], v1, s[28:31], s63 offen offset:512 nt
    v_mfma_f32_16x16x32_bf16 v[64:67], v[108:111], v[44:47], v[64:67]
    s_cbranch_scc1 L_w4
    s_cbranch_vccz L_m4
    s_waitcnt vmcnt(5)
L_m4:
    s_waitcnt vmcnt(6)
L_w4:
    s_cbranch_vccnz L_x4
    s_waitcnt vmcnt(7)
L_x4:
    s_waitcnt vmcnt(8)
    buffer_load_dwordx4 v[108:111], v1, s[28:31], s63 offen offset:768 nt
    v_mfma_f32_16x16x32_bf16 v[64:67], v[112:115], v[48:51], v[64:67]
    s_cbranch_scc1 L_w5
    s_cbranch_vccz L_m5
    s_waitcnt vmcnt(3)
L_m5:
    s_waitcnt vmcnt(6)
L_w5:
    s_cbranch_vccnz L_x5
    s_waitcnt vmcnt(7)
L_x5:
    s_waitcnt vmcnt(8)
    buffer_load_dwordx4 v[112:115], v1, s[28:31], s63 offen offset:1024 nt
    v_mfma_f32_16x16x32_bf16 v[64:67], v[116:119], v[52:55], v[64:67]
    s_cbranch_scc1 L_w6
    s_cbranch_vccz L_m6
    s_waitcnt vmcnt(3)
L_m6:
    s_waitcnt vmcnt(4)
L_w6:
    s_cbranch_vccnz L_x6
    s_waitcnt vmcnt(7)
L_x6:
    s_waitcnt vmcnt(8)
    buffer_load_dwordx4 v[116:119], v1, s[28:31], s63 offen offset:1280 nt
    v_mfma_f32_16x16x32_bf16 v[64:67], v[120:123], v[56:59], v[64:67]
    s_cbranch_scc1 L_w7
    s_cbranch_vccz L_m7
    s_waitcnt vmcnt(3)
L_m7:
    s_waitcnt vmcnt(4)
L_w7:
    s_cbranch_vccnz L_x7
    s_waitcnt vmcnt(5)
L_x7:
    s_waitcnt vmcnt(8)
    buffer_load_dwordx4 v[120:123], v1, s[28:31], s63 offen offset:1536 nt
    v_mfma_f32_16x16x32_bf16 v[64:67], v[124:127], v[60:63], v[64:67]
    s_cbranch_scc1 L_w8
    s_cbranch_vccz L_m8
    s_waitcnt vmcnt(3)
L_m8:
    s_waitcnt vmcnt(4)
L_w8:
    s_cbranch_vccnz L_x8
    s_waitcnt vmcnt(5)
L_x8:
    s_waitcnt vmcnt(6)
    buffer_load_dwordx4 v[124:127], v1, s[28:31], s63 offen offset:1792 nt
    s_add_u32 s63, s63, 0x20000
    s_nop 2
    v_mov_b32_dpp v84, v64 quad_perm:[0,0,0,0] row_mask:0xf bank_mask:0xf
    s_nop 1
    v_add_f32_dpp v84, v65, v84 quad_perm:[1,1,1,1] row_mask:0xf bank_mask:0xf
    s_nop 1
    v_add_f32_dpp v84, v66, v84 quad_perm:[2,2,2,2] row_mask:0xf bank_mask:0xf
    s_nop 1
    v_add_f32_dpp v84, v67, v84 quad_perm:[3,3,3,3] row_mask:0xf bank_mask:0xf
    v_cvt_pk_bf16_f32 v84, v84, v84
    v_and_b32 v84, 0xffff0000, v84
    ds_write_b32 v3, v84 offset:0
    v_max_f32 v6, v6, v84
    v_add_u32 v3, 256, v3
    s_sub_u32 s62, s62, 1
    s_cmp_lg_u32 s62, 0
    s_cbranch_scc1 L_kk
    v_readlane_b32 s15, v245, 16
    v_add_u32_dpp v245, v245, v245 row_ror:8 row_mask:0xf bank_mask:0xf
    s_nop 1
    v_add_u32_dpp v245, v245, v245 row_ror:4 row_mask:0xf bank_mask:0xf
    s_nop 1
    v_add_u32_dpp v245, v245, v245 row_ror:2 row_mask:0xf bank_mask:0xf
    s_nop 1
    v_add_u32_dpp v245, v245, v245 row_ror:1 row_mask:0xf bank_mask:0xf
    v_add_u32 v244, 1, v244
    v_readfirstlane_b32 s65, v245
    s_nop 0
    s_add_u32 s65, s65, s15
    s_mov_b64 exec, 1
    buffer_store_dword v244, v133, s[36:39], s12 offen
    ds_write_b32 v247, v244
    s_mov_b64 exec, 0x1ffff
    buffer_load_dword v245, v246, s[36:39], s13 offen sc1
    s_mov_b64 exec, -1
    s_sub_u32 s17, s65, s14
    s_add_u32 s14, s14, s16
    s_sub_u32 s65, s17, -15
    s_cmp_gt_u32 s65, 23
    s_cselect_b64 vcc, -1, 0
    s_cmp_gt_i32 s17, 0
    v_mfma_f32_16x16x32_bf16 v[64:67], v[96:99], v[32:35], 0
    s_cbranch_scc1 L_w9
    s_cbranch_vccz L_m9
    s_waitcnt vmcnt(5)
L_m9:
    s_waitcnt vmcnt(6)
L_w9:
    s_cbranch_vccnz L_x9
    s_waitcnt vmcnt(7)
L_x9:
    s_waitcnt vmcnt(8)
    buffer_load_dwordx4 v[96:99], v2, s[32:35], s64 offen nt
    v_mfma_f32_16x16x32_bf16 v[64:67], v[100:103], v[36:39], v[64:67]
    s_cbranch_scc1 L_w10
    s_cbranch_vccz L_m10
    s_waitcnt vmcnt(5)
L_m10:
    s_waitcnt vmcnt(6)
L_w10:
    s_cbranch_vccnz L_x10
    s_waitcnt vmcnt(7)
L_x10:
    s_waitcnt vmcnt(8)
    buffer_load_dwordx4 v[100:103], v2, s[32:35], s64 offen offset:256 nt
    v_mfma_f32_16x16x32_bf16 v[64:67], v[104:107], v[40:43], v[64:67]
    s_cbranch_scc1 L_w11
    s_cbranch_vccz L_m11
    s_waitcnt vmcnt(5)
L_m11:
    s_waitcnt vmcnt(6)
L_w11:
    s_cbranch_vccnz L_x11
    s_waitcnt vmcnt(7)
L_x11:
    s_waitcnt vmcnt(8)
    buffer_load_dwordx4 v[104:107], v2, s[32:35], s64 offen offset:512 nt
    v_mfma_f32_16x16x32_bf16 v[64:67], v[108:111], v[44:47], v[64:67]
    s_cbranch_scc1 L_w12
    s_cbranch_vccz L_m12
    s_waitcnt vmcnt(5)
L_m12:
    s_waitcnt vmcnt(6)
L_w12:
    s_cbranch_vccnz L_x12
    s_waitcnt vmcnt(7)
L_x12:
    s_waitcnt vmcnt(8)
    buffer_load_dwordx4 v[108:111], v2, s[32:35], s64 offen offset:768 nt
    v_mfma_f32_16x16x32_bf16 v[64:67], v[112:115], v[48:51], v[64:67]
    s_cbranch_scc1 L_w13
    s_cbranch_vccz L_m13
    s_waitcnt vmcnt(3)
L_m13:
    s_waitcnt vmcnt(6)
L_w13:
    s_cbranch_vccnz L_x13
    s_waitcnt vmcnt(7)
L_x13:
    s_waitcnt vmcnt(8)
    buffer_load_dwordx4 v[112:115], v2, s[32:35], s64 offen offset:1024 nt
    v_mfma_f32_16x16x32_bf16 v[64:67], v[116:119], v[52:55], v[64:67]
    s_cbranch_scc1 L_w14
    s_cbranch_vccz L_m14
    s_waitcnt vmcnt(3)
L_m14:
    s_waitcnt vmcnt(4)
L_w14:
    s_cbranch_vccnz L_x14
    s_waitcnt vmcnt(7)
L_x14:
    s_waitcnt vmcnt(8)
    buffer_load_dwordx4 v[116:119], v2, s[32:35], s64 offen offset:1280 nt
    v_mfma_f32_16x16x32_bf16 v[64:67], v[120:123], v[56:59], v[64:67]
    s_cbranch_scc1 L_w15
    s_cbranch_vccz L_m15
    s_waitcnt vmcnt(3)
L_m15:
    s_waitcnt vmcnt(4)
L_w15:
    s_cbranch_vccnz L_x15
    s_waitcnt vmcnt(5)
L_x15:
    s_waitcnt vmcnt(8)
    buffer_load_dwordx4 v[120:123], v2, s[32:35], s64 offen offset:1536 nt
    v_mfma_f32_16x16x32_bf16 v[64:67], v[124:127], v[60:63], v[64:67]
    s_cbranch_scc1 L_w16
    s_cbranch_vccz L_m16
    s_waitcnt vmcnt(3)
L_m16:
    s_waitcnt vmcnt(4)
L_w16:
    s_cbranch_vccnz L_x16
    s_waitcnt vmcnt(5)
L_x16:
    s_waitcnt vmcnt(6)
    buffer_load_dwordx4 v[124:127], v2, s[32:35], s64 offen offset:1792 nt
    s_add_u32 s64, s64, 0x20000
    s_nop 2
    v_mov_b32_dpp v84, v64 quad_perm:[0,0,0,0] row_mask:0xf bank_mask:0xf
    s_nop 1
    v_add_f32_dpp v84, v65, v84 quad_perm:[1,1,1,1] row_mask:0xf bank_mask:0xf
    s_nop 1
    v_add_f32_dpp v84, v66, v84 quad_perm:[2,2,2,2] row_mask:0xf bank_mask:0xf
    s_nop 1
    v_add_f32_dpp v84, v67, v84 quad_perm:[3,3,3,3] row_mask:0xf bank_mask:0xf
    v_cvt_pk_bf16_f32 v84, v84, v84
    v_and_b32 v84, 0xffff0000, v84
    ds_write_b32 v3, v84 offset:0
    v_max_f32 v6, v6, v84
    v_add_u32 v3, 256, v3
    v_subrev_u32 v3, 4096, v3
    ds_read_b32 v30, v3
    v_max_f32_dpp v6, v6, v6 row_ror:4 row_mask:0xf bank_mask:0xf
    s_nop 1
    v_max_f32_dpp v6, v6, v6 row_ror:8 row_mask:0xf bank_mask:0xf
    s_nop 1
    v_max_f32_dpp v6, v6, v6 row_bcast:15 row_mask:0xa bank_mask:0xf
    s_nop 1
    v_max_f32_dpp v6, v6, v6 row_bcast:31 row_mask:0xc bank_mask:0xf
    s_nop 0
    v_readlane_b32 s65, v6, 63
    s_nop 1
    v_mov_b32 v29, s65
    s_mov_b32 s62, 15
    s_nop 0
L_vv:
    s_waitcnt lgkmcnt(0)
    v_sub_f32 v84, v30, v29
    v_mul_f32 v84, v84, v28
    v_exp_f32 v84, v84
    v_add_u32 v3, 256, v3
    ds_read_b32 v30, v3
    v_add_f32 v7, v7, v84
    v_cvt_pk_bf16_f32 v84, v84, v84
    v_readlane_b32 s15, v245, 16
    v_add_u32_dpp v245, v245, v245 row_ror:8 row_mask:0xf bank_mask:0xf
    s_nop 1
    v_add_u32_dpp v245, v245, v245 row_ror:4 row_mask:0xf bank_mask:0xf
    s_nop 1
    v_add_u32_dpp v245, v245, v245 row_ror:2 row_mask:0xf bank_mask:0xf
    s_nop 1
    v_add_u32_dpp v245, v245, v245 row_ror:1 row_mask:0xf bank_mask:0xf
    v_add_u32 v244, 1, v244
    v_readfirstlane_b32 s65, v245
    s_nop 0
    s_add_u32 s65, s65, s15
    s_mov_b64 exec, 1
    buffer_store_dword v244, v133, s[36:39], s12 offen
    ds_write_b32 v247, v244
    s_mov_b64 exec, 0x1ffff
    buffer_load_dword v245, v246, s[36:39], s13 offen sc1
    s_mov_b64 exec, -1
    s_sub_u32 s17, s65, s14
    s_add_u32 s14, s14, s16
    s_sub_u32 s65, s17, -15
    s_cmp_gt_u32 s65, 23
    s_cselect_b64 vcc, -1, 0
    s_cmp_gt_i32 s17, 0
    v_and_b32_dpp v20, v84, v8 row_newbcast:0 row_mask:0xf bank_mask:0xf
    v_and_b32_dpp v21, v84, v9 row_newbcast:0 row_mask:0xf bank_mask:0xf
    v_and_b32_dpp v22, v84, v10 row_newbcast:0 row_mask:0xf bank_mask:0xf
    v_and_b32_dpp v23, v84, v11 row_newbcast:0 row_mask:0xf bank_mask:0xf
    s_nop 1
    v_mfma_f32_16x16x32_bf16 v[12:15], v[96:99], v[20:23], v[12:15]
    s_cbranch_scc1 L_w17
    s_cbranch_vccz L_m17
    s_waitcnt vmcnt(5)
L_m17:
    s_waitcnt vmcnt(6)
L_w17:
    s_cbranch_vccnz L_x17
    s_waitcnt vmcnt(7)
L_x17:
    s_waitcnt vmcnt(8)
    buffer_load_dwordx4 v[96:99], v2, s[32:35], s64 offen nt
    v_mfma_f32_16x16x32_bf16 v[16:19], v[100:103], v[20:23], v[16:19]
    s_cbranch_scc1 L_w18
    s_cbranch_vccz L_m18
    s_waitcnt vmcnt(5)
L_m18:
    s_waitcnt vmcnt(6)
L_w18:
    s_cbranch_vccnz L_x18
    s_waitcnt vmcnt(7)
L_x18:
    s_waitcnt vmcnt(8)
    buffer_load_dwordx4 v[100:103], v2, s[32:35], s64 offen offset:256 nt
    v_and_b32_dpp v24, v84, v8 row_newbcast:4 row_mask:0xf bank_mask:0xf
    v_and_b32_dpp v25, v84, v9 row_newbcast:4 row_mask:0xf bank_mask:0xf
    v_and_b32_dpp v26, v84, v10 row_newbcast:4 row_mask:0xf bank_mask:0xf
    v_and_b32_dpp v27, v84, v11 row_newbcast:4 row_mask:0xf bank_mask:0xf
    s_nop 1
    v_mfma_f32_16x16x32_bf16 v[12:15], v[104:107], v[24:27], v[12:15]
    s_cbranch_scc1 L_w19
    s_cbranch_vccz L_m19
    s_waitcnt vmcnt(5)
L_m19:
    s_waitcnt vmcnt(6)
L_w19:
    s_cbranch_vccnz L_x19
    s_waitcnt vmcnt(7)
L_x19:
    s_waitcnt vmcnt(8)
    buffer_load_dwordx4 v[104:107], v2, s[32:35], s64 offen offset:512 nt
    v_mfma_f32_16x16x32_bf16 v[16:19], v[108:111], v[24:27], v[16:19]
    s_cbranch_scc1 L_w20
    s_cbranch_vccz L_m20
    s_waitcnt vmcnt(5)
L_m20:
    s_waitcnt vmcnt(6)
L_w20:
    s_cbranch_vccnz L_x20
    s_waitcnt vmcnt(7)
L_x20:
    s_waitcnt vmcnt(8)
    buffer_load_dwordx4 v[108:111], v2, s[32:35], s64 offen offset:768 nt
    v_and_b32_dpp v20, v84, v8 row_newbcast:8 row_mask:0xf bank_mask:0xf
    v_and_b32_dpp v21, v84, v9 row_newbcast:8 row_mask:0xf bank_mask:0xf
    v_and_b32_dpp v22, v84, v10 row_newbcast:8 row_mask:0xf bank_mask:0xf
    v_and_b32_dpp v23, v84, v11 row_newbcast:8 row_mask:0xf bank_mask:0xf
    s_nop 1
    v_mfma_f32_16x16x32_bf16 v[12:15], v[112:115], v[20:23], v[12:15]
    s_cbranch_scc1 L_w21
    s_cbranch_vccz L_m21
    s_waitcnt vmcnt(3)
L_m21:
    s_waitcnt vmcnt(6)
L_w21:
    s_cbranch_vccnz L_x21
    s_waitcnt vmcnt(7)
L_x21:
    s_waitcnt vmcnt(8)
    buffer_load_dwordx4 v[112:115], v2, s[32:35], s64 offen offset:1024 nt
    v_mfma_f32_16x16x32_bf16 v[16:19], v[116:119], v[20:23], v[16:19]
    s_cbranch_scc1 L_w22
    s_cbranch_vccz L_m22
    s_waitcnt vmcnt(3)
L_m22:
    s_waitcnt vmcnt(4)
L_w22:
    s_cbranch_vccnz L_x22
    s_waitcnt vmcnt(7)
L_x22:
    s_waitcnt vmcnt(8)
    buffer_load_dwordx4 v[116:119], v2, s[32:35], s64 offen offset:1280 nt
    v_and_b32_dpp v24, v84, v8 row_newbcast:12 row_mask:0xf bank_mask:0xf
    v_and_b32_dpp v25, v84, v9 row_newbcast:12 row_mask:0xf bank_mask:0xf
    v_and_b32_dpp v26, v84, v10 row_newbcast:12 row_mask:0xf bank_mask:0xf
    v_and_b32_dpp v27, v84, v11 row_newbcast:12 row_mask:0xf bank_mask:0xf
    s_nop 1
    v_mfma_f32_16x16x32_bf16 v[12:15], v[120:123], v[24:27], v[12:15]
    s_cbranch_scc1 L_w23
    s_cbranch_vccz L_m23
    s_waitcnt vmcnt(3)
L_m23:
    s_waitcnt vmcnt(4)
L_w23:
    s_cbranch_vccnz L_x23
    s_waitcnt vmcnt(5)
L_x23:
    s_waitcnt vmcnt(8)
    buffer_load_dwordx4 v[120:123], v2, s[32:35], s64 offen offset:1536 nt
    v_mfma_f32_16x16x32_bf16 v[16:19], v[124:127], v[24:27], v[16:19]
    s_cbranch_scc1 L_w24
    s_cbranch_vccz L_m24
    s_waitcnt vmcnt(3)
L_m24:
    s_waitcnt vmcnt(4)
L_w24:
    s_cbranch_vccnz L_x24
    s_waitcnt vmcnt(5)
L_x24:
    s_waitcnt vmcnt(6)
    buffer_load_dwordx4 v[124:127], v2, s[32:35], s64 offen offset:1792 nt
    s_add_u32 s64, s64, 0x20000
    s_sub_u32 s62, s62, 1
    s_cmp_lg_u32 s62, 0
    s_cbranch_scc1 L_vv
L_tail:
    s_waitcnt lgkmcnt(0)
    v_sub_f32 v84, v30, v29
    v_mul_f32 v84, v84, v28
    v_exp_f32 v84, v84
    s_nop 0
    v_add_f32 v7, v7, v84
    v_cvt_pk_bf16_f32 v84, v84, v84
    s_cmp_eq_u32 s79, 7
    s_cselect_b32 s66, 0x40000000, s66
    s_cselect_b32 s67, 0x40000000, s67
    s_cselect_b32 s69, s69, 0x40000000
    buffer_load_ushort v128, v129, s[52:55], s69 offen
    buffer_load_ushort v243, v129, s[48:51], s69 offen
    v_add_f32_dpp v7, v7, v7 row_ror:4 row_mask:0xf bank_mask:0xf
    s_nop 1
    v_add_f32_dpp v7, v7, v7 row_ror:8 row_mask:0xf bank_mask:0xf
    s_nop 1
    v_add_f32_dpp v7, v7, v7 row_bcast:15 row_mask:0xa bank_mask:0xf
    s_nop 1
    v_add_f32_dpp v7, v7, v7 row_bcast:31 row_mask:0xc bank_mask:0xf
    v_mov_b32 v146, v29
    v_mov_b32 v147, v7
    s_mov_b32 exec_lo, 0
    s_mov_b32 exec_hi, 0x80000000
    ds_write_b64 v131, v[146:147]
    s_mov_b64 exec, -1
    s_waitcnt lgkmcnt(0)
    s_barrier
    ds_read_b128 v[148:151], v133 offset:4128
    ds_read_b128 v[152:155], v133 offset:4144
    s_waitcnt lgkmcnt(0)
    v_max3_f32 v240, v148, v150, v152
    v_max_f32 v240, v240, v154
    v_sub_f32 v148, v148, v240
    v_sub_f32 v150, v150, v240
    v_sub_f32 v152, v152, v240
    v_sub_f32 v154, v154, v240
    v_mul_f32 v148, v148, v28
    v_mul_f32 v150, v150, v28
    v_mul_f32 v152, v152, v28
    v_mul_f32 v154, v154, v28
    v_exp_f32 v148, v148
    v_exp_f32 v150, v150
    v_exp_f32 v152, v152
    v_exp_f32 v154, v154
    v_mul_f32 v241, v148, v149
    v_fmac_f32 v241, v150, v151
    v_fmac_f32 v241, v152, v153
    v_fmac_f32 v241, v154, v155
    v_rcp_f32 v242, v241
    v_log_f32 v241, v241
    v_mul_f32 v148, v148, v242
    v_mul_f32 v150, v150, v242
    v_mul_f32 v152, v152, v242
    v_mul_f32 v154, v154, v242
    v_fma_f32 v166, v240, v28, v241
    v_and_b32_dpp v20, v84, v8 row_newbcast:0 row_mask:0xf bank_mask:0xf
    v_and_b32_dpp v21, v84, v9 row_newbcast:0 row_mask:0xf bank_mask:0xf
    v_and_b32_dpp v22, v84, v10 row_newbcast:0 row_mask:0xf bank_mask:0xf
    v_and_b32_dpp v23, v84, v11 row_newbcast:0 row_mask:0xf bank_mask:0xf
    s_waitcnt vmcnt(9)
    s_nop 0
    v_mfma_f32_16x16x32_bf16 v[12:15], v[96:99], v[20:23], v[12:15]
    s_waitcnt vmcnt(8)
    v_mfma_f32_16x16x32_bf16 v[16:19], v[100:103], v[20:23], v[16:19]
    v_and_b32_dpp v24, v84, v8 row_newbcast:4 row_mask:0xf bank_mask:0xf
    v_and_b32_dpp v25, v84, v9 row_newbcast:4 row_mask:0xf bank_mask:0xf
    v_and_b32_dpp v26, v84, v10 row_newbcast:4 row_mask:0xf bank_mask:0xf
    v_and_b32_dpp v27, v84, v11 row_newbcast:4 row_mask:0xf bank_mask:0xf
    s_waitcnt vmcnt(7)
    s_nop 0
    v_mfma_f32_16x16x32_bf16 v[12:15], v[104:107], v[24:27], v[12:15]
    s_waitcnt vmcnt(6)
    v_mfma_f32_16x16x32_bf16 v[16:19], v[108:111], v[24:27], v[16:19]
    s_add_u32 s65, s67, 0
    s_add_u32 m0, s75, 57344
    s_nop 0
    buffer_load_dwordx4 v144, s[44:47], s65 offen nt lds
    v_and_b32_dpp v20, v84, v8 row_newbcast:8 row_mask:0xf bank_mask:0xf
    v_and_b32_dpp v21, v84, v9 row_newbcast:8 row_mask:0xf bank_mask:0xf
    v_and_b32_dpp v22, v84, v10 row_newbcast:8 row_mask:0xf bank_mask:0xf
    v_and_b32_dpp v23, v84, v11 row_newbcast:8 row_mask:0xf bank_mask:0xf
    s_waitcnt vmcnt(6)
    s_nop 0
    v_mfma_f32_16x16x32_bf16 v[12:15], v[112:115], v[20:23], v[12:15]
    s_add_u32 s65, s67, 28672
    s_add_u32 m0, s75, 61440
    s_nop 0
    buffer_load_dwordx4 v144, s[44:47], s65 offen nt lds
    s_waitcnt vmcnt(6)
    v_mfma_f32_16x16x32_bf16 v[16:19], v[116:119], v[20:23], v[16:19]
    s_add_u32 s65, s66, 0
    s_add_u32 m0, s75, 40960
    s_nop 0
    buffer_load_dwordx4 v143, s[40:43], s65 offen nt lds
    v_and_b32_dpp v24, v84, v8 row_newbcast:12 row_mask:0xf bank_mask:0xf
    v_and_b32_dpp v25, v84, v9 row_newbcast:12 row_mask:0xf bank_mask:0xf
    v_and_b32_dpp v26, v84, v10 row_newbcast:12 row_mask:0xf bank_mask:0xf
    v_and_b32_dpp v27, v84, v11 row_newbcast:12 row_mask:0xf bank_mask:0xf
    s_waitcnt vmcnt(6)
    s_nop 0
    v_mfma_f32_16x16x32_bf16 v[12:15], v[120:123], v[24:27], v[12:15]
    s_add_u32 s65, s66, 114688
    s_add_u32 m0, s75, 45056
    s_nop 0
    buffer_load_dwordx4 v143, s[40:43], s65 offen nt lds
    s_waitcnt vmcnt(6)
    v_mfma_f32_16x16x32_bf16 v[16:19], v[124:127], v[24:27], v[16:19]
    s_nop 7
    v_mov_b32_dpp v12, v16 quad_perm:[0,1,2,3] row_mask:0xf bank_mask:0xc
    v_mov_b32_dpp v13, v17 quad_perm:[0,1,2,3] row_mask:0xf bank_mask:0xc
    v_mov_b32_dpp v14, v18 quad_perm:[0,1,2,3] row_mask:0xf bank_mask:0xc
    v_mov_b32_dpp v15, v19 quad_perm:[0,1,2,3] row_mask:0xf bank_mask:0xc
    ds_write_b128 v130, v[12:15]
    s_add_u32 s65, s66, 28672
    s_add_u32 m0, s75, 49152
    s_nop 0
    buffer_load_dwordx4 v143, s[40:43], s65 offen nt lds
    s_add_u32 s65, s66, 143360
    s_add_u32 m0, s75, 53248
    s_nop 0
    buffer_load_dwordx4 v143, s[40:43], s65 offen nt lds
    s_waitcnt lgkmcnt(0)
    s_barrier
    s_mov_b32 exec_hi, 0
    ds_read_b64 v[156:157], v132 offset:0
    ds_read_b64 v[158:159], v132 offset:1024
    ds_read_b64 v[160:161], v132 offset:2048
    ds_read_b64 v[162:163], v132 offset:3072
    s_cmp_lg_u32 s101, 0
    s_waitcnt lgkmcnt(3)
    v_pk_mul_f32 v[164:165], v[156:157], v[148:149] op_sel_hi:[1,0]
    s_waitcnt lgkmcnt(2)
    v_pk_fma_f32 v[164:165], v[158:159], v[150:151], v[164:165] op_sel_hi:[1,0,1]
    s_waitcnt lgkmcnt(1)
    v_pk_fma_f32 v[164:165], v[160:161], v[152:153], v[164:165] op_sel_hi:[1,0,1]
    s_waitcnt lgkmcnt(0)
    v_pk_fma_f32 v[164:165], v[162:163], v[154:155], v[164:165] op_sel_hi:[1,0,1]
    s_cbranch_scc1 L_st1far
    buffer_store_dwordx4 v[164:167], v134, s[36:39], s70 offen
    s_branch L_st1done
L_st1far:
    buffer_store_dwordx4 v[164:167], v134, s[36:39], s70 offen sc1
L_st1done:
    s_mov_b64 exec, -1
    s_mov_b32 s62, 262144
    s_cmp_eq_u32 s79, 7
    s_cbranch_scc1 L_reduce
    buffer_load_dwordx4 v[168:171], v134, s[36:39], s71 offen sc1
    buffer_load_dwordx4 v[172:175], v134, s[36:39], s71 offen offset:2048 sc1
    buffer_load_dwordx4 v[176:179], v134, s[36:39], s74 offen sc1
    buffer_load_dwordx4 v[180:183], v134, s[36:39], s74 offen offset:2048 sc1
    ds_read_b128 v[184:187], v140 offset:4224
    ds_read_b128 v[188:191], v140 offset:4288
L_p1:
    s_waitcnt vmcnt(0)
L_p1c:
    v_cmp_ne_u32 s[4:5], s61, v171
    v_cmp_ne_u32 s[6:7], s61, v175
    v_cmp_ne_u32 s[8:9], s61, v179
    v_cmp_ne_u32 s[10:11], s61, v183
    s_or_b64 s[76:77], s[4:5], s[6:7]
    s_or_b64 vcc, s[8:9], s[10:11]
    s_or_b64 s[76:77], s[76:77], vcc
    s_cbranch_scc0 L_p1ok
    s_cmp_eq_u64 s[4:5], 0
    s_cbranch_scc1 L_p1s0
    buffer_load_dwordx4 v[168:171], v134, s[36:39], s71 offen sc1
L_p1s0:
    s_cmp_eq_u64 s[6:7], 0
    s_cbranch_scc1 L_p1s1
    buffer_load_dwordx4 v[172:175], v134, s[36:39], s71 offen offset:2048 sc1
L_p1s1:
    s_cmp_eq_u64 s[8:9], 0
    s_cbranch_scc1 L_p1s2
    buffer_load_dwordx4 v[176:179], v134, s[36:39], s74 offen sc1
L_p1s2:
    s_cmp_eq_u64 s[10:11], 0
    s_cbranch_scc1 L_p1s3
    buffer_load_dwordx4 v[180:183], v134, s[36:39], s74 offen offset:2048 sc1
L_p1s3:
    s_sub_u32 s62, s62, 1
    s_cbranch_scc0 L_p1
L_p1ok:
    v_max3_f32 v240, v170, v174, v178
    v_max_f32 v240, v240, v182
    v_sub_f32 v170, v170, v240
    v_sub_f32 v174, v174, v240
    v_sub_f32 v178, v178, v240
    v_sub_f32 v182, v182, v240
    v_exp_f32 v170, v170
    v_exp_f32 v174, v174
    v_exp_f32 v178, v178
    v_exp_f32 v182, v182
    v_add_f32 v241, v170, v174
    v_pk_mul_f32 v[148:149], v[168:169], v[170:171] op_sel_hi:[1,0]
    v_add_f32 v242, v178, v182
    v_pk_fma_f32 v[148:149], v[172:173], v[174:175], v[148:149] op_sel_hi:[1,0,1]
    v_add_f32 v242, v241, v242
    v_pk_fma_f32 v[148:149], v[176:177], v[178:179], v[148:149] op_sel_hi:[1,0,1]
    v_rcp_f32 v242, v242
    v_pk_fma_f32 v[148:149], v[180:181], v[182:183], v[148:149] op_sel_hi:[1,0,1]
    v_pk_mul_f32 v[148:149], v[148:149], v[242:243] op_sel_hi:[1,0]
    v_cvt_pk_bf16_f32 v148, v148, v149
    ds_write_b32 v142, v148
    s_waitcnt vmcnt(0) lgkmcnt(0)
    s_barrier
    ds_read_b64_tr_b16 v[224:225], v136 offset:57344
    ds_read_b64_tr_b16 v[226:227], v136 offset:57856
    ds_read_b64_tr_b16 v[228:229], v136 offset:61440
    ds_read_b64_tr_b16 v[230:231], v136 offset:61952
    ds_read_b128 v[192:195], v141 offset:4864
    ds_read_b64_tr_b16 v[208:209], v136 offset:40960
    ds_read_b64_tr_b16 v[210:211], v136 offset:41472
    ds_read_b128 v[196:199], v141 offset:4928
    ds_read_b64_tr_b16 v[212:213], v136 offset:45056
    ds_read_b64_tr_b16 v[214:215], v136 offset:45568
    ds_read_b128 v[200:203], v141 offset:4992
    ds_read_b64_tr_b16 v[216:217], v136 offset:49152
    ds_read_b64_tr_b16 v[218:219], v136 offset:49664
    ds_read_b128 v[204:207], v141 offset:5056
    ds_read_b64_tr_b16 v[220:221], v136 offset:53248
    ds_read_b64_tr_b16 v[222:223], v136 offset:53760
    s_waitcnt lgkmcnt(12)
    v_mfma_f32_16x16x32_bf16 v[232:235], v[184:187], v[224:227], 0
    v_mfma_f32_16x16x32_bf16 v[232:235], v[188:191], v[228:231], v[232:235]
    s_waitcnt lgkmcnt(9)
    v_mfma_f32_16x16x32_bf16 v[232:235], v[192:195], v[208:211], v[232:235]
    s_waitcnt lgkmcnt(6)
    v_mfma_f32_16x16x32_bf16 v[232:235], v[196:199], v[212:215], v[232:235]
    s_waitcnt lgkmcnt(3)
    v_mfma_f32_16x16x32_bf16 v[232:235], v[200:203], v[216:219], v[232:235]
    s_waitcnt lgkmcnt(0)
    v_mfma_f32_16x16x32_bf16 v[232:235], v[204:207], v[220:223], v[232:235]
    s_nop 7
    v_mov_b32 v233, v167
    buffer_store_dwordx2 v[232:233], v135, s[36:39], s68 offen sc1
    buffer_store_dwordx2 v[232:233], v135, s[36:39], s19 offen sc1
    s_branch L_sdone
L_reduce:
    s_cmp_ge_u32 s100, 28
    s_cbranch_scc1 L_sdone
    ds_read_b32 v236, v133 offset:4104
    s_waitcnt lgkmcnt(0)
    v_readfirstlane_b32 s65, v236
    s_nop 0
    s_and_b32 s65, s65, 0x2000
    s_add_u32 s78, s78, s65
    s_waitcnt vmcnt(0)
    v_lshlrev_b32 v128, 16, v128
    buffer_load_dwordx4 v[96:99], v134, s[36:39], s78 offen offset:0 sc1
    buffer_load_dwordx4 v[100:103], v134, s[36:39], s78 offen offset:1024 sc1
    buffer_load_dwordx4 v[104:107], v134, s[36:39], s78 offen offset:2048 sc1
    buffer_load_dwordx4 v[108:111], v134, s[36:39], s78 offen offset:3072 sc1
    s_sleep 4
L_p2:
    buffer_load_dwordx4 v[112:115], v134, s[36:39], s78 offen offset:0 sc1
    buffer_load_dwordx4 v[116:119], v134, s[36:39], s78 offen offset:1024 sc1
    buffer_load_dwordx4 v[120:123], v134, s[36:39], s78 offen offset:2048 sc1
    buffer_load_dwordx4 v[124:127], v134, s[36:39], s78 offen offset:3072 sc1
    s_waitcnt vmcnt(4)
    v_xor_b32 v236, v97, v167
    v_xor_b32 v237, v99, v167
    v_bitop3_b32 v236, v101, v167, v236 bitop3:0xbe
    v_bitop3_b32 v237, v103, v167, v237 bitop3:0xbe
    v_bitop3_b32 v236, v105, v167, v236 bitop3:0xbe
    v_bitop3_b32 v237, v107, v167, v237 bitop3:0xbe
    v_bitop3_b32 v236, v109, v167, v236 bitop3:0xbe
    v_bitop3_b32 v237, v111, v167, v237 bitop3:0xbe
    v_or_b32 v236, v236, v237
    v_add_f32 v168, v96, v100
    v_add_f32 v170, v98, v102
    v_cmp_ne_u32 vcc, 0, v236
    v_add_f32 v176, v104, v108
    v_add_f32 v178, v106, v110
    s_cbranch_vccz L_p2ok
    buffer_load_dwordx4 v[96:99], v134, s[36:39], s78 offen offset:0 sc1
    buffer_load_dwordx4 v[100:103], v134, s[36:39], s78 offen offset:1024 sc1
    buffer_load_dwordx4 v[104:107], v134, s[36:39], s78 offen offset:2048 sc1
    buffer_load_dwordx4 v[108:111], v134, s[36:39], s78 offen offset:3072 sc1
    s_waitcnt vmcnt(4)
    v_xor_b32 v236, v113, v167
    v_xor_b32 v237, v115, v167
    v_bitop3_b32 v236, v117, v167, v236 bitop3:0xbe
    v_bitop3_b32 v237, v119, v167, v237 bitop3:0xbe
    v_bitop3_b32 v236, v121, v167, v236 bitop3:0xbe
    v_bitop3_b32 v237, v123, v167, v237 bitop3:0xbe
    v_bitop3_b32 v236, v125, v167, v236 bitop3:0xbe
    v_bitop3_b32 v237, v127, v167, v237 bitop3:0xbe
    v_or_b32 v236, v236, v237
    v_add_f32 v168, v112, v116
    v_add_f32 v170, v114, v118
    v_cmp_ne_u32 vcc, 0, v236
    v_add_f32 v176, v120, v124
    v_add_f32 v178, v122, v126
    s_cbranch_vccz L_p2ok
    s_sub_u32 s62, s62, 1
    s_cbranch_scc0 L_p2
L_p2ok:
    v_add_f32 v168, v168, v176
    v_add_f32 v170, v170, v178
    s_nop 1
    v_permlane16_swap_b32 v168, v170
    v_add_f32 v168, v168, v170
    s_nop 1
    v_add_f32_dpp v168, v168, v168 row_ror:8 row_mask:0xf bank_mask:0xf
    v_mov_b32 v170, v168
    s_nop 1
    v_permlane32_swap_b32 v168, v170
    v_add_f32 v168, v168, v170
    v_add_f32 v168, v168, v128
    v_cvt_pk_bf16_f32 v168, v168, v168
    s_mov_b32 exec_hi, 0
    s_mov_b32 exec_lo, 0x00ff00ff
    buffer_store_short v168, v129, s[48:51], s69 offen
    s_or_b32 s65, s100, s72
    s_cmp_lg_u32 s65, 0
    s_cbranch_scc1 L_sdone
    s_mov_b64 exec, 1
    buffer_store_dword v167, v133, s[36:39], 0 offen
L_sdone:
    s_endpgm
L_helper:
    s_load_dwordx16 s[4:19], s[0:1], 0
    s_load_dwordx8 s[20:27], s[0:1], 64
    s_and_b32 s60, s2, 63
    s_lshr_b32 s58, s2, 6
    s_lshr_b32 s56, s60, 4
    s_and_b32 s57, s2, 15
    s_lshl_b32 s2, s60, 2
    s_or_b32 s2, s2, s58
    s_and_b32 s59, s2, 63
    s_lshl_b32 s73, s57, 1
    s_and_b32 s65, s58, 1
    s_or_b32 s73, s73, s65
    s_lshl_b32 s79, s56, 1
    s_lshr_b32 s65, s58, 1
    s_or_b32 s79, s79, s65
    v_and_b32 v0, 63, v0
    v_and_b32 v4, 15, v0
    v_lshrrev_b32 v5, 4, v0
    s_setprio 3
    v_mul_u32_u24 v6, 896, v5
    v_lshl_add_u32 v6, v4, 6, v6
    v_mov_b32 v7, 0x40000000
    v_cmp_gt_u32 s[74:75], 14, v4
    s_nop 1
    v_cndmask_b32 v7, v7, v6, s[74:75]
    v_lshrrev_b32 v8, 3, v0
    v_and_b32 v9, 7, v0
    v_lshlrev_b32 v9, 4, v9
    v_lshl_add_u32 v10, v8, 13, v9
    v_mul_u32_u24 v11, 3584, v8
    v_add_u32 v11, v11, v9
    s_mul_i32 s65, s56, 917504
    s_lshl_b32 s66, s59, 7
    s_add_u32 s65, s65, s66
    s_waitcnt lgkmcnt(0)
    s_load_dword s61, s[26:27], 0
    s_mov_b32 s40, s4
    s_mov_b32 s41, s5
    s_mov_b32 s42, 3584
    s_mov_b32 s43, 0x20000
    buffer_load_dwordx4 v[32:35], v7, s[40:43], 0 offen offset:0
    buffer_load_dwordx4 v[36:39], v7, s[40:43], 0 offen offset:16
    buffer_load_dwordx4 v[40:43], v7, s[40:43], 0 offen offset:32
    buffer_load_dwordx4 v[44:47], v7, s[40:43], 0 offen offset:48
    s_mov_b32 s44, s10
    s_mov_b32 s45, s11
    s_mov_b32 s46, 3670016
    s_mov_b32 s47, 0x20000
    s_mov_b32 m0, 26624
    s_nop 0
    buffer_load_dwordx4 v10, s[44:47], s65 offen nt lds
    s_add_u32 s65, s65, 65536
    s_mov_b32 m0, 27648
    s_nop 0
    buffer_load_dwordx4 v10, s[44:47], s65 offen nt lds
    s_add_u32 s65, s65, 65536
    s_mov_b32 m0, 28672
    s_nop 0
    buffer_load_dwordx4 v10, s[44:47], s65 offen nt lds
    s_add_u32 s65, s65, 65536
    s_mov_b32 m0, 29696
    s_nop 0
    buffer_load_dwordx4 v10, s[44:47], s65 offen nt lds
    s_add_u32 s65, s65, 65536
    s_mov_b32 m0, 30720
    s_nop 0
    buffer_load_dwordx4 v10, s[44:47], s65 offen nt lds
    s_add_u32 s65, s65, 65536
    s_mov_b32 m0, 31744
    s_nop 0
    buffer_load_dwordx4 v10, s[44:47], s65 offen nt lds
    s_add_u32 s65, s65, 65536
    s_mov_b32 m0, 32768
    s_nop 0
    buffer_load_dwordx4 v10, s[44:47], s65 offen nt lds
    s_add_u32 s65, s65, 65536
    s_mov_b32 m0, 33792
    s_nop 0
    buffer_load_dwordx4 v10, s[44:47], s65 offen nt lds
    s_add_u32 s65, s65, 65536
    s_mov_b32 m0, 34816
    s_nop 0
    buffer_load_dwordx4 v10, s[44:47], s65 offen nt lds
    s_add_u32 s65, s65, 65536
    s_mov_b32 m0, 35840
    s_nop 0
    buffer_load_dwordx4 v10, s[44:47], s65 offen nt lds
    s_add_u32 s65, s65, 65536
    s_mov_b32 m0, 36864
    s_nop 0
    buffer_load_dwordx4 v10, s[44:47], s65 offen nt lds
    s_add_u32 s65, s65, 65536
    s_mov_b32 m0, 37888
    s_nop 0
    buffer_load_dwordx4 v10, s[44:47], s65 offen nt lds
    s_add_u32 s65, s65, 65536
    s_mov_b32 m0, 38912
    s_nop 0
    buffer_load_dwordx4 v10, s[44:47], s65 offen nt lds
    s_add_u32 s65, s65, 65536
    s_mov_b32 m0, 39936
    s_nop 0
    buffer_load_dwordx4 v10, s[44:47], s65 offen nt lds
    s_mov_b32 s36, s26
    s_mov_b32 s37, s27
    s_mov_b32 s38, 4259840
    s_mov_b32 s39, 0x20000
    s_lshl_b32 s34, s57, 9
    s_add_u32 s34, s34, 32768
    s_lshl_b32 s35, s56, 2
    s_add_u32 s35, s35, s58
    s_lshl_b32 s68, s35, 2
    s_add_u32 s68, s68, s34
    v_lshlrev_b32 v2, 7, v0
    v_mov_b32 v3, 0
    s_mov_b64 exec, 15
    buffer_store_dword v3, v2, s[36:39], s68 offen
    s_cmp_eq_u32 s35, 0
    s_cselect_b32 s68, s34, 0x40000000
    buffer_store_dword v3, v2, s[36:39], s68 offen offset:64
    s_mov_b64 exec, -1
    v_and_b32 v14, 3, v4
    v_lshrrev_b32 v15, 2, v4
    s_mul_i32 s65, s56, 224
    v_mul_u32_u24 v12, 896, v15
    v_add_u32 v12, s65, v12
    v_lshl_add_u32 v28, v5, 3, v12
    v_lshl_add_u32 v12, v5, 4, v12
    s_lshr_b32 s65, s79, 1
    s_mul_i32 s65, s65, 224
    v_mul_u32_u24 v30, 896, v14
    v_add_u32 v30, s65, v30
    v_lshl_add_u32 v31, v5, 3, v30
    v_lshl_add_u32 v30, v5, 4, v30
    v_lshl_add_u32 v8, v5, 2, v14
    v_lshlrev_b32 v8, 4, v8
    v_lshl_add_u32 v8, v15, 16, v8
    v_lshlrev_b32 v9, 5, v14
    v_lshl_add_u32 v9, v15, 3, v9
    v_lshl_add_u32 v9, v5, 7, v9
    v_cmp_eq_u32 s[28:29], 1, v14
    v_cmp_eq_u32 s[30:31], 2, v14
    v_cmp_eq_u32 s[32:33], 3, v14
    v_lshlrev_b32 v15, 7, v15
    v_lshl_add_u32 v15, v14, 3, v15
    v_lshl_add_u32 v13, v5, 10, v15
    v_lshl_add_u32 v29, v5, 9, v15
    s_waitcnt vmcnt(14)
    v_lshlrev_b32 v64, 16, v32
    v_and_b32 v65, 0xffff0000, v32
    v_lshlrev_b32 v66, 16, v33
    v_and_b32 v67, 0xffff0000, v33
    v_lshlrev_b32 v68, 16, v34
    v_and_b32 v69, 0xffff0000, v34
    v_lshlrev_b32 v70, 16, v35
    v_and_b32 v71, 0xffff0000, v35
    v_lshlrev_b32 v72, 16, v36
    v_and_b32 v73, 0xffff0000, v36
    v_lshlrev_b32 v74, 16, v37
    v_and_b32 v75, 0xffff0000, v37
    v_lshlrev_b32 v76, 16, v38
    v_and_b32 v77, 0xffff0000, v38
    v_lshlrev_b32 v78, 16, v39
    v_and_b32 v79, 0xffff0000, v39
    v_lshlrev_b32 v80, 16, v40
    v_and_b32 v81, 0xffff0000, v40
    v_lshlrev_b32 v82, 16, v41
    v_and_b32 v83, 0xffff0000, v41
    v_lshlrev_b32 v84, 16, v42
    v_and_b32 v85, 0xffff0000, v42
    v_lshlrev_b32 v86, 16, v43
    v_and_b32 v87, 0xffff0000, v43
    v_lshlrev_b32 v88, 16, v44
    v_and_b32 v89, 0xffff0000, v44
    v_lshlrev_b32 v90, 16, v45
    v_and_b32 v91, 0xffff0000, v45
    v_lshlrev_b32 v92, 16, v46
    v_and_b32 v93, 0xffff0000, v46
    v_lshlrev_b32 v94, 16, v47
    v_and_b32 v95, 0xffff0000, v47
    v_pk_add_f32 v[14:15], v[64:65], v[66:67]
    v_pk_add_f32 v[16:17], v[68:69], v[70:71]
    v_pk_add_f32 v[14:15], v[14:15], v[72:73]
    v_pk_add_f32 v[16:17], v[16:17], v[74:75]
    v_pk_add_f32 v[14:15], v[14:15], v[76:77]
    v_pk_add_f32 v[16:17], v[16:17], v[78:79]
    v_pk_add_f32 v[14:15], v[14:15], v[80:81]
    v_pk_add_f32 v[16:17], v[16:17], v[82:83]
    v_pk_add_f32 v[14:15], v[14:15], v[84:85]
    v_pk_add_f32 v[16:17], v[16:17], v[86:87]
    v_pk_add_f32 v[14:15], v[14:15], v[88:89]
    v_pk_add_f32 v[16:17], v[16:17], v[90:91]
    v_pk_add_f32 v[14:15], v[14:15], v[92:93]
    v_pk_add_f32 v[16:17], v[16:17], v[94:95]
    v_pk_add_f32 v[14:15], v[14:15], v[16:17]
    v_add_f32 v14, v14, v15
    s_nop 1
    v_add_f32_dpp v14, v14, v14 row_ror:8 row_mask:0xf bank_mask:0xf
    s_nop 1
    v_add_f32_dpp v14, v14, v14 row_ror:4 row_mask:0xf bank_mask:0xf
    s_nop 1
    v_add_f32_dpp v14, v14, v14 row_ror:2 row_mask:0xf bank_mask:0xf
    s_nop 1
    v_add_f32_dpp v14, v14, v14 row_ror:1 row_mask:0xf bank_mask:0xf
    v_mul_f32 v18, 0xbb124925, v14
    v_mov_b32 v19, v18
    v_mov_b32 v14, 0
    v_mov_b32 v15, 0
    v_mov_b32 v16, 0
    v_mov_b32 v17, 0
    v_pk_add_f32 v[20:21], v[64:65], v[18:19]
    v_pk_add_f32 v[22:23], v[66:67], v[18:19]
    v_pk_fma_f32 v[14:15], v[20:21], v[20:21], v[14:15]
    v_pk_fma_f32 v[16:17], v[22:23], v[22:23], v[16:17]
    v_pk_add_f32 v[20:21], v[68:69], v[18:19]
    v_pk_add_f32 v[22:23], v[70:71], v[18:19]
    v_pk_fma_f32 v[14:15], v[20:21], v[20:21], v[14:15]
    v_pk_fma_f32 v[16:17], v[22:23], v[22:23], v[16:17]
    v_pk_add_f32 v[20:21], v[72:73], v[18:19]
    v_pk_add_f32 v[22:23], v[74:75], v[18:19]
    v_pk_fma_f32 v[14:15], v[20:21], v[20:21], v[14:15]
    v_pk_fma_f32 v[16:17], v[22:23], v[22:23], v[16:17]
    v_pk_add_f32 v[20:21], v[76:77], v[18:19]
    v_pk_add_f32 v[22:23], v[78:79], v[18:19]
    v_pk_fma_f32 v[14:15], v[20:21], v[20:21], v[14:15]
    v_pk_fma_f32 v[16:17], v[22:23], v[22:23], v[16:17]
    v_pk_add_f32 v[20:21], v[80:81], v[18:19]
    v_pk_add_f32 v[22:23], v[82:83], v[18:19]
    v_pk_fma_f32 v[14:15], v[20:21], v[20:21], v[14:15]
    v_pk_fma_f32 v[16:17], v[22:23], v[22:23], v[16:17]
    v_pk_add_f32 v[20:21], v[84:85], v[18:19]
    v_pk_add_f32 v[22:23], v[86:87], v[18:19]
    v_pk_fma_f32 v[14:15], v[20:21], v[20:21], v[14:15]
    v_pk_fma_f32 v[16:17], v[22:23], v[22:23], v[16:17]
    v_pk_add_f32 v[20:21], v[88:89], v[18:19]
    v_pk_add_f32 v[22:23], v[90:91], v[18:19]
    v_pk_fma_f32 v[14:15], v[20:21], v[20:21], v[14:15]
    v_pk_fma_f32 v[16:17], v[22:23], v[22:23], v[16:17]
    v_pk_add_f32 v[20:21], v[92:93], v[18:19]
    v_pk_add_f32 v[22:23], v[94:95], v[18:19]
    v_pk_fma_f32 v[14:15], v[20:21], v[20:21], v[14:15]
    v_pk_fma_f32 v[16:17], v[22:23], v[22:23], v[16:17]
    v_pk_add_f32 v[14:15], v[14:15], v[16:17]
    v_add_f32 v14, v14, v15
    v_cndmask_b32 v14, 0, v14, s[74:75]
    s_nop 1
    v_add_f32_dpp v14, v14, v14 row_ror:8 row_mask:0xf bank_mask:0xf
    s_nop 1
    v_add_f32_dpp v14, v14, v14 row_ror:4 row_mask:0xf bank_mask:0xf
    s_nop 1
    v_add_f32_dpp v14, v14, v14 row_ror:2 row_mask:0xf bank_mask:0xf
    s_nop 1
    v_add_f32_dpp v14, v14, v14 row_ror:1 row_mask:0xf bank_mask:0xf
    v_mul_f32 v14, 0x3b124925, v14
    v_cvt_pk_bf16_f32 v14, v14, v14
    v_and_b32 v14, 0xffff0000, v14
    v_add_f32 v14, 0x3727c5ac, v14
    v_cvt_pk_bf16_f32 v14, v14, v14
    v_and_b32 v14, 0xffff0000, v14
    v_sqrt_f32 v14, v14
    s_nop 0
    v_cvt_pk_bf16_f32 v14, v14, v14
    v_and_b32 v14, 0xffff0000, v14
    v_rcp_f32 v16, v14
    v_mov_b32 v15, v14
    v_cvt_pk_bf16_f32 v18, v18, v18
    v_and_b32 v18, 0xffff0000, v18
    v_mov_b32 v17, v16
    v_mov_b32 v19, v18
    v_pk_add_f32 v[64:65], v[64:65], v[18:19]
    v_pk_add_f32 v[66:67], v[66:67], v[18:19]
    v_pk_add_f32 v[68:69], v[68:69], v[18:19]
    v_pk_add_f32 v[70:71], v[70:71], v[18:19]
    v_pk_add_f32 v[72:73], v[72:73], v[18:19]
    v_pk_add_f32 v[74:75], v[74:75], v[18:19]
    v_pk_add_f32 v[76:77], v[76:77], v[18:19]
    v_pk_add_f32 v[78:79], v[78:79], v[18:19]
    v_pk_add_f32 v[80:81], v[80:81], v[18:19]
    v_pk_add_f32 v[82:83], v[82:83], v[18:19]
    v_pk_add_f32 v[84:85], v[84:85], v[18:19]
    v_pk_add_f32 v[86:87], v[86:87], v[18:19]
    v_pk_add_f32 v[88:89], v[88:89], v[18:19]
    v_pk_add_f32 v[90:91], v[90:91], v[18:19]
    v_pk_add_f32 v[92:93], v[92:93], v[18:19]
    v_pk_add_f32 v[94:95], v[94:95], v[18:19]
    v_cvt_pk_bf16_f32 v32, v64, v65
    v_cvt_pk_bf16_f32 v33, v66, v67
    v_cvt_pk_bf16_f32 v34, v68, v69
    v_cvt_pk_bf16_f32 v35, v70, v71
    v_cvt_pk_bf16_f32 v36, v72, v73
    v_cvt_pk_bf16_f32 v37, v74, v75
    v_cvt_pk_bf16_f32 v38, v76, v77
    v_cvt_pk_bf16_f32 v39, v78, v79
    v_cvt_pk_bf16_f32 v40, v80, v81
    v_cvt_pk_bf16_f32 v41, v82, v83
    v_cvt_pk_bf16_f32 v42, v84, v85
    v_cvt_pk_bf16_f32 v43, v86, v87
    v_cvt_pk_bf16_f32 v44, v88, v89
    v_cvt_pk_bf16_f32 v45, v90, v91
    v_cvt_pk_bf16_f32 v46, v92, v93
    v_cvt_pk_bf16_f32 v47, v94, v95
    v_lshlrev_b32 v64, 16, v32
    v_and_b32 v65, 0xffff0000, v32
    v_lshlrev_b32 v66, 16, v33
    v_and_b32 v67, 0xffff0000, v33
    v_lshlrev_b32 v68, 16, v34
    v_and_b32 v69, 0xffff0000, v34
    v_lshlrev_b32 v70, 16, v35
    v_and_b32 v71, 0xffff0000, v35
    v_lshlrev_b32 v72, 16, v36
    v_and_b32 v73, 0xffff0000, v36
    v_lshlrev_b32 v74, 16, v37
    v_and_b32 v75, 0xffff0000, v37
    v_lshlrev_b32 v76, 16, v38
    v_and_b32 v77, 0xffff0000, v38
    v_lshlrev_b32 v78, 16, v39
    v_and_b32 v79, 0xffff0000, v39
    v_lshlrev_b32 v80, 16, v40
    v_and_b32 v81, 0xffff0000, v40
    v_lshlrev_b32 v82, 16, v41
    v_and_b32 v83, 0xffff0000, v41
    v_lshlrev_b32 v84, 16, v42
    v_and_b32 v85, 0xffff0000, v42
    v_lshlrev_b32 v86, 16, v43
    v_and_b32 v87, 0xffff0000, v43
    v_lshlrev_b32 v88, 16, v44
    v_and_b32 v89, 0xffff0000, v44
    v_lshlrev_b32 v90, 16, v45
    v_and_b32 v91, 0xffff0000, v45
    v_lshlrev_b32 v92, 16, v46
    v_and_b32 v93, 0xffff0000, v46
    v_lshlrev_b32 v94, 16, v47
    v_and_b32 v95, 0xffff0000, v47
    v_pk_mul_f32 v[20:21], v[64:65], v[16:17]
    v_pk_fma_f32 v[64:65], v[20:21], v[14:15], v[64:65] neg_lo:[1,0,0] neg_hi:[1,0,0]
    v_pk_fma_f32 v[20:21], v[64:65], v[16:17], v[20:21]
    v_cvt_pk_bf16_f32 v32, v20, v21
    v_pk_mul_f32 v[22:23], v[66:67], v[16:17]
    v_pk_fma_f32 v[66:67], v[22:23], v[14:15], v[66:67] neg_lo:[1,0,0] neg_hi:[1,0,0]
    v_pk_fma_f32 v[22:23], v[66:67], v[16:17], v[22:23]
    v_cvt_pk_bf16_f32 v33, v22, v23
    v_pk_mul_f32 v[24:25], v[68:69], v[16:17]
    v_pk_fma_f32 v[68:69], v[24:25], v[14:15], v[68:69] neg_lo:[1,0,0] neg_hi:[1,0,0]
    v_pk_fma_f32 v[24:25], v[68:69], v[16:17], v[24:25]
    v_cvt_pk_bf16_f32 v34, v24, v25
    v_pk_mul_f32 v[26:27], v[70:71], v[16:17]
    v_pk_fma_f32 v[70:71], v[26:27], v[14:15], v[70:71] neg_lo:[1,0,0] neg_hi:[1,0,0]
    v_pk_fma_f32 v[26:27], v[70:71], v[16:17], v[26:27]
    v_cvt_pk_bf16_f32 v35, v26, v27
    v_pk_mul_f32 v[20:21], v[72:73], v[16:17]
    v_pk_fma_f32 v[72:73], v[20:21], v[14:15], v[72:73] neg_lo:[1,0,0] neg_hi:[1,0,0]
    v_pk_fma_f32 v[20:21], v[72:73], v[16:17], v[20:21]
    v_cvt_pk_bf16_f32 v36, v20, v21
    v_pk_mul_f32 v[22:23], v[74:75], v[16:17]
    v_pk_fma_f32 v[74:75], v[22:23], v[14:15], v[74:75] neg_lo:[1,0,0] neg_hi:[1,0,0]
    v_pk_fma_f32 v[22:23], v[74:75], v[16:17], v[22:23]
    v_cvt_pk_bf16_f32 v37, v22, v23
    v_pk_mul_f32 v[24:25], v[76:77], v[16:17]
    v_pk_fma_f32 v[76:77], v[24:25], v[14:15], v[76:77] neg_lo:[1,0,0] neg_hi:[1,0,0]
    v_pk_fma_f32 v[24:25], v[76:77], v[16:17], v[24:25]
    v_cvt_pk_bf16_f32 v38, v24, v25
    v_pk_mul_f32 v[26:27], v[78:79], v[16:17]
    v_pk_fma_f32 v[78:79], v[26:27], v[14:15], v[78:79] neg_lo:[1,0,0] neg_hi:[1,0,0]
    v_pk_fma_f32 v[26:27], v[78:79], v[16:17], v[26:27]
    v_cvt_pk_bf16_f32 v39, v26, v27
    v_pk_mul_f32 v[20:21], v[80:81], v[16:17]
    v_pk_fma_f32 v[80:81], v[20:21], v[14:15], v[80:81] neg_lo:[1,0,0] neg_hi:[1,0,0]
    v_pk_fma_f32 v[20:21], v[80:81], v[16:17], v[20:21]
    v_cvt_pk_bf16_f32 v40, v20, v21
    v_pk_mul_f32 v[22:23], v[82:83], v[16:17]
    v_pk_fma_f32 v[82:83], v[22:23], v[14:15], v[82:83] neg_lo:[1,0,0] neg_hi:[1,0,0]
    v_pk_fma_f32 v[22:23], v[82:83], v[16:17], v[22:23]
    v_cvt_pk_bf16_f32 v41, v22, v23
    v_pk_mul_f32 v[24:25], v[84:85], v[16:17]
    v_pk_fma_f32 v[84:85], v[24:25], v[14:15], v[84:85] neg_lo:[1,0,0] neg_hi:[1,0,0]
    v_pk_fma_f32 v[24:25], v[84:85], v[16:17], v[24:25]
    v_cvt_pk_bf16_f32 v42, v24, v25
    v_pk_mul_f32 v[26:27], v[86:87], v[16:17]
    v_pk_fma_f32 v[86:87], v[26:27], v[14:15], v[86:87] neg_lo:[1,0,0] neg_hi:[1,0,0]
    v_pk_fma_f32 v[26:27], v[86:87], v[16:17], v[26:27]
    v_cvt_pk_bf16_f32 v43, v26, v27
    v_pk_mul_f32 v[20:21], v[88:89], v[16:17]
    v_pk_fma_f32 v[88:89], v[20:21], v[14:15], v[88:89] neg_lo:[1,0,0] neg_hi:[1,0,0]
    v_pk_fma_f32 v[20:21], v[88:89], v[16:17], v[20:21]
    v_cvt_pk_bf16_f32 v44, v20, v21
    v_pk_mul_f32 v[22:23], v[90:91], v[16:17]
    v_pk_fma_f32 v[90:91], v[22:23], v[14:15], v[90:91] neg_lo:[1,0,0] neg_hi:[1,0,0]
    v_pk_fma_f32 v[22:23], v[90:91], v[16:17], v[22:23]
    v_cvt_pk_bf16_f32 v45, v22, v23
    v_pk_mul_f32 v[24:25], v[92:93], v[16:17]
    v_pk_fma_f32 v[92:93], v[24:25], v[14:15], v[92:93] neg_lo:[1,0,0] neg_hi:[1,0,0]
    v_pk_fma_f32 v[24:25], v[92:93], v[16:17], v[24:25]
    v_cvt_pk_bf16_f32 v46, v24, v25
    v_pk_mul_f32 v[26:27], v[94:95], v[16:17]
    v_pk_fma_f32 v[94:95], v[26:27], v[14:15], v[94:95] neg_lo:[1,0,0] neg_hi:[1,0,0]
    v_pk_fma_f32 v[26:27], v[94:95], v[16:17], v[26:27]
    v_cvt_pk_bf16_f32 v47, v26, v27
    s_mov_b64 exec, s[74:75]
    ds_write_b128 v6, v[32:35] offset:0
    ds_write_b128 v6, v[36:39] offset:16
    ds_write_b128 v6, v[40:43] offset:32
    ds_write_b128 v6, v[44:47] offset:48
    s_mov_b64 exec, -1
    s_waitcnt lgkmcnt(0)
    s_mul_i32 s61, s61, 0x9E3779B1
    s_add_u32 s61, s61, 0x7F4A7C15
    ds_read_b128 v[96:99], v12 offset:0
    ds_read_b128 v[100:103], v12 offset:64
    ds_read_b128 v[104:107], v12 offset:128
    ds_read_b64 v[108:109], v28 offset:192
    v_mov_b32 v200, s61
    v_lshrrev_b32 v201, 8, v200
    v_lshrrev_b32 v202, 16, v200
    v_lshrrev_b32 v203, 24, v200
    s_movk_i32 s78, 0xff
    v_lshlrev_b32 v10, 4, v0
    s_lshl_b32 s66, s57, 12
    s_lshl_b32 s67, s56, 10
    s_add_u32 s66, s66, s67
    s_lshl_b32 s67, s58, 8
    s_add_u32 s66, s66, s67
    s_add_u32 s66, s66, 65536
    s_lshl_b32 s67, s60, 12
    s_add_u32 s67, s67, 65536
    s_waitcnt vmcnt(0)
    s_getreg_b32 s69, hwreg(HW_REG_XCC_ID, 0, 4)
    v_xor_b32 v204, s69, v203
    ds_read_b64_tr_b16 v[128:129], v13 offset:26624
    ds_read_b64_tr_b16 v[130:131], v13 offset:27136
    ds_read_b64_tr_b16 v[132:133], v13 offset:30720
    ds_read_b64_tr_b16 v[134:135], v13 offset:31232
    ds_read_b64_tr_b16 v[136:137], v13 offset:34816
    ds_read_b64_tr_b16 v[138:139], v13 offset:35328
    ds_read_b64_tr_b16 v[140:141], v29 offset:38912
    ds_read_b64_tr_b16 v[142:143], v13 offset:26656
    ds_read_b64_tr_b16 v[144:145], v13 offset:27168
    ds_read_b64_tr_b16 v[146:147], v13 offset:30752
    ds_read_b64_tr_b16 v[148:149], v13 offset:31264
    ds_read_b64_tr_b16 v[150:151], v13 offset:34848
    ds_read_b64_tr_b16 v[152:153], v13 offset:35360
    ds_read_b64_tr_b16 v[154:155], v29 offset:38944
    ds_read_b64_tr_b16 v[156:157], v13 offset:26688
    ds_read_b64_tr_b16 v[158:159], v13 offset:27200
    ds_read_b64_tr_b16 v[160:161], v13 offset:30784
    ds_read_b64_tr_b16 v[162:163], v13 offset:31296
    ds_read_b64_tr_b16 v[164:165], v13 offset:34880
    ds_read_b64_tr_b16 v[166:167], v13 offset:35392
    ds_read_b64_tr_b16 v[168:169], v29 offset:38976
    ds_read_b64_tr_b16 v[170:171], v13 offset:26720
    ds_read_b64_tr_b16 v[172:173], v13 offset:27232
    ds_read_b64_tr_b16 v[174:175], v13 offset:30816
    ds_read_b64_tr_b16 v[176:177], v13 offset:31328
    ds_read_b64_tr_b16 v[178:179], v13 offset:34912
    ds_read_b64_tr_b16 v[180:181], v13 offset:35424
    ds_read_b64_tr_b16 v[182:183], v29 offset:39008
    s_waitcnt lgkmcnt(0)
    v_mfma_f32_16x16x32_bf16 v[184:187], v[128:131], v[96:99], 0
    v_mfma_f32_16x16x32_bf16 v[188:191], v[142:145], v[96:99], 0
    v_mfma_f32_16x16x32_bf16 v[192:195], v[156:159], v[96:99], 0
    v_mfma_f32_16x16x32_bf16 v[196:199], v[170:173], v[96:99], 0
    v_mfma_f32_16x16x32_bf16 v[184:187], v[132:135], v[100:103], v[184:187]
    v_mfma_f32_16x16x32_bf16 v[188:191], v[146:149], v[100:103], v[188:191]
    v_mfma_f32_16x16x32_bf16 v[192:195], v[160:163], v[100:103], v[192:195]
    v_mfma_f32_16x16x32_bf16 v[196:199], v[174:177], v[100:103], v[196:199]
    v_mfma_f32_16x16x32_bf16 v[184:187], v[136:139], v[104:107], v[184:187]
    v_mfma_f32_16x16x32_bf16 v[188:191], v[150:153], v[104:107], v[188:191]
    v_mfma_f32_16x16x32_bf16 v[192:195], v[164:167], v[104:107], v[192:195]
    v_mfma_f32_16x16x32_bf16 v[196:199], v[178:181], v[104:107], v[196:199]
    v_mfma_f32_16x16x16_bf16 v[184:187], v[140:141], v[108:109], v[184:187]
    v_mfma_f32_16x16x16_bf16 v[188:191], v[154:155], v[108:109], v[188:191]
    v_mfma_f32_16x16x16_bf16 v[192:195], v[168:169], v[108:109], v[192:195]
    v_mfma_f32_16x16x16_bf16 v[196:199], v[182:183], v[108:109], v[196:199]
    s_nop 5
    v_cndmask_b32 v184, v184, v188, s[28:29]
    v_cndmask_b32 v185, v185, v189, s[28:29]
    v_cndmask_b32 v186, v186, v190, s[28:29]
    v_cndmask_b32 v187, v187, v191, s[28:29]
    v_cndmask_b32 v184, v184, v192, s[30:31]
    v_cndmask_b32 v185, v185, v193, s[30:31]
    v_cndmask_b32 v186, v186, v194, s[30:31]
    v_cndmask_b32 v187, v187, v195, s[30:31]
    v_cndmask_b32 v184, v184, v196, s[32:33]
    v_cndmask_b32 v185, v185, v197, s[32:33]
    v_cndmask_b32 v186, v186, v198, s[32:33]
    v_cndmask_b32 v187, v187, v199, s[32:33]
    v_add_u32 v184, 0x80, v184
    v_add_u32 v185, 0x80, v185
    v_add_u32 v186, 0x80, v186
    v_add_u32 v187, 0x80, v187
    v_bfi_b32 v20, s78, v200, v184
    v_bfi_b32 v21, s78, v201, v185
    v_bfi_b32 v22, s78, v202, v186
    v_bfi_b32 v23, s78, v204, v187
    buffer_store_dwordx4 v[20:23], v8, s[36:39], s66 offen
    ds_read_b128 v[112:115], v30 offset:0
    ds_read_b128 v[116:119], v30 offset:64
    ds_read_b128 v[120:123], v30 offset:128
    ds_read_b64 v[124:125], v31 offset:192
    v_mov_b32 v16, 0
    v_mov_b32 v17, 0
    v_mov_b32 v18, 0
    v_mov_b32 v19, 0
    s_mov_b32 exec_hi, 0xff
    ds_write_b128 v10, v[16:19] offset:4224
    s_mov_b64 exec, -1
    ds_write_b128 v16, v[16:19] offset:4112
    s_sleep 30
    buffer_load_dwordx4 v[64:67], v10, s[36:39], s67 offen offset:0 sc1
    buffer_load_dwordx4 v[68:71], v10, s[36:39], s67 offen offset:1024 sc1
    buffer_load_dwordx4 v[72:75], v10, s[36:39], s67 offen offset:2048 sc1
    buffer_load_dwordx4 v[76:79], v10, s[36:39], s67 offen offset:3072 sc1
    s_mov_b32 s62, 262144
L_pq:
    s_waitcnt vmcnt(0)
    v_xor_b32 v36, v67, v204
    v_and_b32 v32, 0xf0, v36
    v_bitop3_b32 v32, v64, v200, v32 bitop3:0xbe
    v_bitop3_b32 v32, v65, v201, v32 bitop3:0xbe
    v_bitop3_b32 v32, v66, v202, v32 bitop3:0xbe
    v_and_b32 v32, s78, v32
    v_xor_b32 v37, v71, v204
    v_and_b32 v33, 0xf0, v37
    v_bitop3_b32 v33, v68, v200, v33 bitop3:0xbe
    v_bitop3_b32 v33, v69, v201, v33 bitop3:0xbe
    v_bitop3_b32 v33, v70, v202, v33 bitop3:0xbe
    v_and_b32 v33, s78, v33
    v_xor_b32 v38, v75, v204
    v_and_b32 v34, 0xf0, v38
    v_bitop3_b32 v34, v72, v200, v34 bitop3:0xbe
    v_bitop3_b32 v34, v73, v201, v34 bitop3:0xbe
    v_bitop3_b32 v34, v74, v202, v34 bitop3:0xbe
    v_and_b32 v34, s78, v34
    v_xor_b32 v39, v79, v204
    v_and_b32 v35, 0xf0, v39
    v_bitop3_b32 v35, v76, v200, v35 bitop3:0xbe
    v_bitop3_b32 v35, v77, v201, v35 bitop3:0xbe
    v_bitop3_b32 v35, v78, v202, v35 bitop3:0xbe
    v_and_b32 v35, s78, v35
    v_or3_b32 v24, v32, v33, v34
    v_or_b32 v24, v24, v35
    v_cmp_ne_u32 vcc, 0, v24
    s_cbranch_vccz L_pqok
    s_cmp_lg_u32 s62, 262139
    s_cbranch_scc1 L_pqg
    buffer_store_dwordx4 v[20:23], v8, s[36:39], s66 offen sc1
L_pqg:
    s_sleep 2
    v_cmp_ne_u32 vcc, 0, v32
    s_cbranch_vccz L_pqs0
    buffer_load_dwordx4 v[64:67], v10, s[36:39], s67 offen offset:0 sc1
L_pqs0:
    v_cmp_ne_u32 vcc, 0, v33
    s_cbranch_vccz L_pqs1
    buffer_load_dwordx4 v[68:71], v10, s[36:39], s67 offen offset:1024 sc1
L_pqs1:
    v_cmp_ne_u32 vcc, 0, v34
    s_cbranch_vccz L_pqs2
    buffer_load_dwordx4 v[72:75], v10, s[36:39], s67 offen offset:2048 sc1
L_pqs2:
    v_cmp_ne_u32 vcc, 0, v35
    s_cbranch_vccz L_pqs3
    buffer_load_dwordx4 v[76:79], v10, s[36:39], s67 offen offset:3072 sc1
L_pqs3:
    s_sub_u32 s62, s62, 1
    s_cmp_lg_u32 s62, 0
    s_cbranch_scc1 L_pq
L_pqok:
    v_and_b32 v64, 0xffffff00, v64
    v_and_b32 v65, 0xffffff00, v65
    v_and_b32 v66, 0xffffff00, v66
    v_and_b32 v67, 0xffffff00, v67
    v_and_b32 v68, 0xffffff00, v68
    v_and_b32 v69, 0xffffff00, v69
    v_and_b32 v70, 0xffffff00, v70
    v_and_b32 v71, 0xffffff00, v71
    v_and_b32 v72, 0xffffff00, v72
    v_and_b32 v73, 0xffffff00, v73
    v_and_b32 v74, 0xffffff00, v74
    v_and_b32 v75, 0xffffff00, v75
    v_and_b32 v76, 0xffffff00, v76
    v_and_b32 v77, 0xffffff00, v77
    v_and_b32 v78, 0xffffff00, v78
    v_and_b32 v79, 0xffffff00, v79
    v_pk_add_f32 v[64:65], v[64:65], v[68:69]
    v_pk_add_f32 v[72:73], v[72:73], v[76:77]
    v_pk_add_f32 v[66:67], v[66:67], v[70:71]
    v_pk_add_f32 v[74:75], v[74:75], v[78:79]
    v_pk_add_f32 v[64:65], v[64:65], v[72:73]
    v_pk_add_f32 v[66:67], v[66:67], v[74:75]
    v_cvt_pk_bf16_f32 v24, v64, v65
    v_cvt_pk_bf16_f32 v25, v66, v67
    v_mov_b32 v17, 0
    v_or3_b32 v26, v36, v37, v38
    v_or_b32 v26, v26, v39
    v_and_b32 v26, 15, v26
    v_cmp_ne_u32 vcc, 0, v26
    s_nop 0
    s_or_b32 s69, vcc_lo, vcc_hi
    v_mov_b32 v26, v200
    v_mov_b32 v27, s69
    ds_write_b64 v9, v[24:25] offset:3584
    ds_write_b64 v17, v[26:27] offset:4096
    s_cmp_eq_u32 s69, 0
    s_cbranch_scc1 L_qnear
    buffer_store_dwordx4 v[20:23], v8, s[36:39], s66 offen sc1
    s_nop 1
L_qnear:
    s_waitcnt lgkmcnt(0)
    s_barrier
    s_setprio 0
    s_cmp_lg_u32 s35, 15
    s_cbranch_scc1 L_nog0
    s_cmp_lg_u32 s69, 0
    s_cbranch_scc1 L_nog0
    s_mov_b32 s71, 1
    s_atomic_add s71, s[24:25], 60 glc
    s_waitcnt lgkmcnt(0)
    s_sub_u32 s71, s71, 8
    s_mul_i32 s71, s71, 4
    s_ashr_i32 s71, s71, 2
    v_mov_b32 v42, s71
    s_mov_b64 exec, 15
    buffer_store_dword v42, v2, s[36:39], s34 offen offset:64
    s_mov_b64 exec, -1
L_nog0:
    s_cmp_ge_u32 s73, 28
    s_cbranch_scc1 L_hend
    s_bitcmp1_b32 s79, 0
    s_cselect_b32 s48, s18, s16
    s_cselect_b32 s49, s19, s17
    s_mov_b32 s50, 1605632
    s_mov_b32 s51, 0x20000
    s_lshr_b32 s66, s79, 1
    s_mul_i32 s65, s66, 401408
    s_lshl_b32 s67, s73, 7
    s_add_u32 s65, s65, s67
    s_mov_b32 m0, 26624
    s_nop 0
    buffer_load_dwordx4 v11, s[48:51], s65 offen nt lds
    s_add_u32 s65, s65, 28672
    s_mov_b32 m0, 27648
    s_nop 0
    buffer_load_dwordx4 v11, s[48:51], s65 offen nt lds
    s_add_u32 s65, s65, 28672
    s_mov_b32 m0, 28672
    s_nop 0
    buffer_load_dwordx4 v11, s[48:51], s65 offen nt lds
    s_add_u32 s65, s65, 28672
    s_mov_b32 m0, 29696
    s_nop 0
    buffer_load_dwordx4 v11, s[48:51], s65 offen nt lds
    s_add_u32 s65, s65, 28672
    s_waitcnt vmcnt(3)
    s_mov_b32 m0, 30720
    s_nop 0
    buffer_load_dwordx4 v11, s[48:51], s65 offen nt lds
    s_add_u32 s65, s65, 28672
    s_waitcnt vmcnt(3)
    s_mov_b32 m0, 31744
    s_nop 0
    buffer_load_dwordx4 v11, s[48:51], s65 offen nt lds
    s_add_u32 s65, s65, 28672
    s_waitcnt vmcnt(3)
    s_mov_b32 m0, 32768
    s_nop 0
    buffer_load_dwordx4 v11, s[48:51], s65 offen nt lds
    s_add_u32 s65, s65, 28672
    s_waitcnt vmcnt(3)
    s_mov_b32 m0, 33792
    s_nop 0
    buffer_load_dwordx4 v11, s[48:51], s65 offen nt lds
    s_add_u32 s65, s65, 28672
    s_waitcnt vmcnt(3)
    s_mov_b32 m0, 34816
    s_nop 0
    buffer_load_dwordx4 v11, s[48:51], s65 offen nt lds
    s_add_u32 s65, s65, 28672
    s_waitcnt vmcnt(3)
    s_mov_b32 m0, 35840
    s_nop 0
    buffer_load_dwordx4 v11, s[48:51], s65 offen nt lds
    s_add_u32 s65, s65, 28672
    s_waitcnt vmcnt(3)
    s_mov_b32 m0, 36864
    s_nop 0
    buffer_load_dwordx4 v11, s[48:51], s65 offen nt lds
    s_add_u32 s65, s65, 28672
    s_waitcnt vmcnt(3)
    s_mov_b32 m0, 37888
    s_nop 0
    buffer_load_dwordx4 v11, s[48:51], s65 offen nt lds
    s_add_u32 s65, s65, 28672
    s_waitcnt vmcnt(3)
    s_mov_b32 m0, 38912
    s_nop 0
    buffer_load_dwordx4 v11, s[48:51], s65 offen nt lds
    s_add_u32 s65, s65, 28672
    s_waitcnt vmcnt(3)
    s_mov_b32 m0, 39936
    s_nop 0
    buffer_load_dwordx4 v11, s[48:51], s65 offen nt lds
    s_lshl_b32 s67, s73, 13
    s_add_u32 s67, s67, 327680
    s_lshl_b32 s66, s79, 10
    s_add_u32 s66, s66, s67
    s_add_u32 s68, s67, 4096
    s_waitcnt vmcnt(0)
    ds_read_b64_tr_b16 v[128:129], v13 offset:26624
    ds_read_b64_tr_b16 v[130:131], v13 offset:27136
    ds_read_b64_tr_b16 v[132:133], v13 offset:30720
    ds_read_b64_tr_b16 v[134:135], v13 offset:31232
    ds_read_b64_tr_b16 v[136:137], v13 offset:34816
    ds_read_b64_tr_b16 v[138:139], v13 offset:35328
    ds_read_b64_tr_b16 v[140:141], v29 offset:38912
    ds_read_b64_tr_b16 v[142:143], v13 offset:26656
    ds_read_b64_tr_b16 v[144:145], v13 offset:27168
    ds_read_b64_tr_b16 v[146:147], v13 offset:30752
    ds_read_b64_tr_b16 v[148:149], v13 offset:31264
    ds_read_b64_tr_b16 v[150:151], v13 offset:34848
    ds_read_b64_tr_b16 v[152:153], v13 offset:35360
    ds_read_b64_tr_b16 v[154:155], v29 offset:38944
    ds_read_b64_tr_b16 v[156:157], v13 offset:26688
    ds_read_b64_tr_b16 v[158:159], v13 offset:27200
    ds_read_b64_tr_b16 v[160:161], v13 offset:30784
    ds_read_b64_tr_b16 v[162:163], v13 offset:31296
    ds_read_b64_tr_b16 v[164:165], v13 offset:34880
    ds_read_b64_tr_b16 v[166:167], v13 offset:35392
    ds_read_b64_tr_b16 v[168:169], v29 offset:38976
    ds_read_b64_tr_b16 v[170:171], v13 offset:26720
    ds_read_b64_tr_b16 v[172:173], v13 offset:27232
    ds_read_b64_tr_b16 v[174:175], v13 offset:30816
    ds_read_b64_tr_b16 v[176:177], v13 offset:31328
    ds_read_b64_tr_b16 v[178:179], v13 offset:34912
    ds_read_b64_tr_b16 v[180:181], v13 offset:35424
    ds_read_b64_tr_b16 v[182:183], v29 offset:39008
    s_waitcnt lgkmcnt(0)
    v_mfma_f32_16x16x32_bf16 v[184:187], v[112:115], v[128:131], 0
    v_mfma_f32_16x16x32_bf16 v[188:191], v[112:115], v[142:145], 0
    v_mfma_f32_16x16x32_bf16 v[192:195], v[112:115], v[156:159], 0
    v_mfma_f32_16x16x32_bf16 v[196:199], v[112:115], v[170:173], 0
    v_mfma_f32_16x16x32_bf16 v[184:187], v[116:119], v[132:135], v[184:187]
    v_mfma_f32_16x16x32_bf16 v[188:191], v[116:119], v[146:149], v[188:191]
    v_mfma_f32_16x16x32_bf16 v[192:195], v[116:119], v[160:163], v[192:195]
    v_mfma_f32_16x16x32_bf16 v[196:199], v[116:119], v[174:177], v[196:199]
    v_mfma_f32_16x16x32_bf16 v[184:187], v[120:123], v[136:139], v[184:187]
    v_mfma_f32_16x16x32_bf16 v[188:191], v[120:123], v[150:153], v[188:191]
    v_mfma_f32_16x16x32_bf16 v[192:195], v[120:123], v[164:167], v[192:195]
    v_mfma_f32_16x16x32_bf16 v[196:199], v[120:123], v[178:181], v[196:199]
    v_mfma_f32_16x16x16_bf16 v[184:187], v[124:125], v[140:141], v[184:187]
    v_mfma_f32_16x16x16_bf16 v[188:191], v[124:125], v[154:155], v[188:191]
    v_mfma_f32_16x16x16_bf16 v[192:195], v[124:125], v[168:169], v[192:195]
    v_mfma_f32_16x16x16_bf16 v[196:199], v[124:125], v[182:183], v[196:199]
    s_nop 5
    v_mov_b32_dpp v184, v188 quad_perm:[0,1,2,3] row_mask:0x2 bank_mask:0xf
    v_mov_b32_dpp v185, v189 quad_perm:[0,1,2,3] row_mask:0x2 bank_mask:0xf
    v_mov_b32_dpp v186, v190 quad_perm:[0,1,2,3] row_mask:0x2 bank_mask:0xf
    v_mov_b32_dpp v187, v191 quad_perm:[0,1,2,3] row_mask:0x2 bank_mask:0xf
    v_mov_b32_dpp v184, v192 quad_perm:[0,1,2,3] row_mask:0x4 bank_mask:0xf
    v_mov_b32_dpp v185, v193 quad_perm:[0,1,2,3] row_mask:0x4 bank_mask:0xf
    v_mov_b32_dpp v186, v194 quad_perm:[0,1,2,3] row_mask:0x4 bank_mask:0xf
    v_mov_b32_dpp v187, v195 quad_perm:[0,1,2,3] row_mask:0x4 bank_mask:0xf
    v_mov_b32_dpp v184, v196 quad_perm:[0,1,2,3] row_mask:0x8 bank_mask:0xf
    v_mov_b32_dpp v185, v197 quad_perm:[0,1,2,3] row_mask:0x8 bank_mask:0xf
    v_mov_b32_dpp v186, v198 quad_perm:[0,1,2,3] row_mask:0x8 bank_mask:0xf
    v_mov_b32_dpp v187, v199 quad_perm:[0,1,2,3] row_mask:0x8 bank_mask:0xf
    v_add_u32 v184, 0x80, v184
    v_add_u32 v185, 0x80, v185
    v_add_u32 v186, 0x80, v186
    v_add_u32 v187, 0x80, v187
    v_bfi_b32 v20, s78, v200, v184
    v_bfi_b32 v21, s78, v201, v185
    v_bfi_b32 v22, s78, v202, v186
    v_bfi_b32 v23, s78, v203, v187
    s_cmp_lg_u32 s69, 0
    s_cbranch_scc1 L_ffar
    buffer_store_dwordx4 v[20:23], v10, s[36:39], s66 offen
    s_nop 0
    s_branch L_fdone
L_ffar:
    buffer_store_dwordx4 v[20:23], v10, s[36:39], s66 offen sc1
    s_nop 1
L_fdone:
    s_cmp_eq_u32 s79, 7
    s_cbranch_scc1 L_hend
    s_sleep 60
    buffer_load_dwordx4 v[64:67], v10, s[36:39], s67 offen offset:0 sc1
    buffer_load_dwordx4 v[68:71], v10, s[36:39], s67 offen offset:1024 sc1
    buffer_load_dwordx4 v[72:75], v10, s[36:39], s67 offen offset:2048 sc1
    buffer_load_dwordx4 v[76:79], v10, s[36:39], s67 offen offset:3072 sc1
    buffer_load_dwordx4 v[80:83], v10, s[36:39], s68 offen offset:0 sc1
    buffer_load_dwordx4 v[84:87], v10, s[36:39], s68 offen offset:1024 sc1
    buffer_load_dwordx4 v[88:91], v10, s[36:39], s68 offen offset:2048 sc1
    buffer_load_dwordx4 v[92:95], v10, s[36:39], s68 offen offset:3072 sc1
    s_mov_b32 s62, 262144
    v_lshlrev_b32 v9, 1, v0
    s_nop 1
L_pf:
    s_waitcnt vmcnt(0)
    v_xor_b32 v32, v64, v200
    v_bitop3_b32 v32, v65, v201, v32 bitop3:0xbe
    v_bitop3_b32 v32, v66, v202, v32 bitop3:0xbe
    v_bitop3_b32 v32, v67, v203, v32 bitop3:0xbe
    v_and_b32 v32, s78, v32
    v_xor_b32 v33, v68, v200
    v_bitop3_b32 v33, v69, v201, v33 bitop3:0xbe
    v_bitop3_b32 v33, v70, v202, v33 bitop3:0xbe
    v_bitop3_b32 v33, v71, v203, v33 bitop3:0xbe
    v_and_b32 v33, s78, v33
    v_xor_b32 v34, v72, v200
    v_bitop3_b32 v34, v73, v201, v34 bitop3:0xbe
    v_bitop3_b32 v34, v74, v202, v34 bitop3:0xbe
    v_bitop3_b32 v34, v75, v203, v34 bitop3:0xbe
    v_and_b32 v34, s78, v34
    v_xor_b32 v35, v76, v200
    v_bitop3_b32 v35, v77, v201, v35 bitop3:0xbe
    v_bitop3_b32 v35, v78, v202, v35 bitop3:0xbe
    v_bitop3_b32 v35, v79, v203, v35 bitop3:0xbe
    v_and_b32 v35, s78, v35
    v_xor_b32 v36, v80, v200
    v_bitop3_b32 v36, v81, v201, v36 bitop3:0xbe
    v_bitop3_b32 v36, v82, v202, v36 bitop3:0xbe
    v_bitop3_b32 v36, v83, v203, v36 bitop3:0xbe
    v_and_b32 v36, s78, v36
    v_xor_b32 v37, v84, v200
    v_bitop3_b32 v37, v85, v201, v37 bitop3:0xbe
    v_bitop3_b32 v37, v86, v202, v37 bitop3:0xbe
    v_bitop3_b32 v37, v87, v203, v37 bitop3:0xbe
    v_and_b32 v37, s78, v37
    v_xor_b32 v38, v88, v200
    v_bitop3_b32 v38, v89, v201, v38 bitop3:0xbe
    v_bitop3_b32 v38, v90, v202, v38 bitop3:0xbe
    v_bitop3_b32 v38, v91, v203, v38 bitop3:0xbe
    v_and_b32 v38, s78, v38
    v_xor_b32 v39, v92, v200
    v_bitop3_b32 v39, v93, v201, v39 bitop3:0xbe
    v_bitop3_b32 v39, v94, v202, v39 bitop3:0xbe
    v_bitop3_b32 v39, v95, v203, v39 bitop3:0xbe
    v_and_b32 v39, s78, v39
    v_or3_b32 v24, v32, v33, v34
    v_or3_b32 v24, v24, v35, v36
    v_or3_b32 v24, v24, v37, v38
    v_or_b32 v24, v24, v39
    v_cmp_ne_u32 vcc, 0, v24
    s_cbranch_vccz L_pfok
    s_sleep 16
    v_cmp_ne_u32 vcc, 0, v32
    s_cbranch_vccz L_pfs0
    buffer_load_dwordx4 v[64:67], v10, s[36:39], s67 offen offset:0 sc1
L_pfs0:
    v_cmp_ne_u32 vcc, 0, v33
    s_cbranch_vccz L_pfs1
    buffer_load_dwordx4 v[68:71], v10, s[36:39], s67 offen offset:1024 sc1
L_pfs1:
    v_cmp_ne_u32 vcc, 0, v34
    s_cbranch_vccz L_pfs2
    buffer_load_dwordx4 v[72:75], v10, s[36:39], s67 offen offset:2048 sc1
L_pfs2:
    v_cmp_ne_u32 vcc, 0, v35
    s_cbranch_vccz L_pfs3
    buffer_load_dwordx4 v[76:79], v10, s[36:39], s67 offen offset:3072 sc1
L_pfs3:
    v_cmp_ne_u32 vcc, 0, v36
    s_cbranch_vccz L_pfs4
    buffer_load_dwordx4 v[80:83], v10, s[36:39], s68 offen offset:0 sc1
L_pfs4:
    v_cmp_ne_u32 vcc, 0, v37
    s_cbranch_vccz L_pfs5
    buffer_load_dwordx4 v[84:87], v10, s[36:39], s68 offen offset:1024 sc1
L_pfs5:
    v_cmp_ne_u32 vcc, 0, v38
    s_cbranch_vccz L_pfs6
    buffer_load_dwordx4 v[88:91], v10, s[36:39], s68 offen offset:2048 sc1
L_pfs6:
    v_cmp_ne_u32 vcc, 0, v39
    s_cbranch_vccz L_pfs7
    buffer_load_dwordx4 v[92:95], v10, s[36:39], s68 offen offset:3072 sc1
L_pfs7:
    s_sub_u32 s62, s62, 1
    s_cbranch_scc0 L_pf
L_pfok:
    v_and_b32 v64, 0xffffff00, v64
    v_and_b32 v65, 0xffffff00, v65
    v_and_b32 v66, 0xffffff00, v66
    v_and_b32 v67, 0xffffff00, v67
    v_and_b32 v68, 0xffffff00, v68
    v_and_b32 v69, 0xffffff00, v69
    v_and_b32 v70, 0xffffff00, v70
    v_and_b32 v71, 0xffffff00, v71
    v_and_b32 v72, 0xffffff00, v72
    v_and_b32 v73, 0xffffff00, v73
    v_and_b32 v74, 0xffffff00, v74
    v_and_b32 v75, 0xffffff00, v75
    v_and_b32 v76, 0xffffff00, v76
    v_and_b32 v77, 0xffffff00, v77
    v_and_b32 v78, 0xffffff00, v78
    v_and_b32 v79, 0xffffff00, v79
    v_and_b32 v80, 0xffffff00, v80
    v_and_b32 v81, 0xffffff00, v81
    v_and_b32 v82, 0xffffff00, v82
    v_and_b32 v83, 0xffffff00, v83
    v_and_b32 v84, 0xffffff00, v84
    v_and_b32 v85, 0xffffff00, v85
    v_and_b32 v86, 0xffffff00, v86
    v_and_b32 v87, 0xffffff00, v87
    v_and_b32 v88, 0xffffff00, v88
    v_and_b32 v89, 0xffffff00, v89
    v_and_b32 v90, 0xffffff00, v90
    v_and_b32 v91, 0xffffff00, v91
    v_and_b32 v92, 0xffffff00, v92
    v_and_b32 v93, 0xffffff00, v93
    v_and_b32 v94, 0xffffff00, v94
    v_and_b32 v95, 0xffffff00, v95
    v_pk_add_f32 v[64:65], v[64:65], v[72:73]
    v_pk_add_f32 v[80:81], v[80:81], v[88:89]
    v_pk_add_f32 v[66:67], v[66:67], v[74:75]
    v_pk_add_f32 v[82:83], v[82:83], v[90:91]
    v_pk_add_f32 v[68:69], v[68:69], v[76:77]
    v_pk_add_f32 v[84:85], v[84:85], v[92:93]
    v_pk_add_f32 v[70:71], v[70:71], v[78:79]
    v_pk_add_f32 v[86:87], v[86:87], v[94:95]
    v_pk_add_f32 v[64:65], v[64:65], v[80:81]
    v_pk_add_f32 v[66:67], v[66:67], v[82:83]
    v_pk_add_f32 v[68:69], v[68:69], v[84:85]
    v_pk_add_f32 v[70:71], v[70:71], v[86:87]
    v_cvt_pk_bf16_f32 v64, v64, v64
    v_and_b32 v64, 0xffff0000, v64
    v_cvt_pk_bf16_f32 v65, v65, v65
    v_and_b32 v65, 0xffff0000, v65
    v_cvt_pk_bf16_f32 v66, v66, v66
    v_and_b32 v66, 0xffff0000, v66
    v_cvt_pk_bf16_f32 v67, v67, v67
    v_and_b32 v67, 0xffff0000, v67
    v_cvt_pk_bf16_f32 v68, v68, v68
    v_and_b32 v68, 0xffff0000, v68
    v_cvt_pk_bf16_f32 v69, v69, v69
    v_and_b32 v69, 0xffff0000, v69
    v_cvt_pk_bf16_f32 v70, v70, v70
    v_and_b32 v70, 0xffff0000, v70
    v_cvt_pk_bf16_f32 v71, v71, v71
    v_and_b32 v71, 0xffff0000, v71
    v_mul_f32 v72, v64, v64
    v_mul_f32 v72, 0x3d372713, v72
    v_fma_f32 v72, v72, v64, v64
    v_mul_f32 v72, 0xc0135761, v72
    v_exp_f32 v72, v72
    s_nop 0
    v_add_f32 v72, 1.0, v72
    v_rcp_f32 v72, v72
    s_nop 0
    v_mul_f32 v64, v64, v72
    v_cvt_pk_bf16_f32 v64, v64, v64
    v_and_b32 v64, 0xffff0000, v64
    v_mul_f32 v64, v64, v68
    v_mul_f32 v73, v65, v65
    v_mul_f32 v73, 0x3d372713, v73
    v_fma_f32 v73, v73, v65, v65
    v_mul_f32 v73, 0xc0135761, v73
    v_exp_f32 v73, v73
    s_nop 0
    v_add_f32 v73, 1.0, v73
    v_rcp_f32 v73, v73
    s_nop 0
    v_mul_f32 v65, v65, v73
    v_cvt_pk_bf16_f32 v65, v65, v65
    v_and_b32 v65, 0xffff0000, v65
    v_mul_f32 v65, v65, v69
    v_mul_f32 v74, v66, v66
    v_mul_f32 v74, 0x3d372713, v74
    v_fma_f32 v74, v74, v66, v66
    v_mul_f32 v74, 0xc0135761, v74
    v_exp_f32 v74, v74
    s_nop 0
    v_add_f32 v74, 1.0, v74
    v_rcp_f32 v74, v74
    s_nop 0
    v_mul_f32 v66, v66, v74
    v_cvt_pk_bf16_f32 v66, v66, v66
    v_and_b32 v66, 0xffff0000, v66
    v_mul_f32 v66, v66, v70
    v_mul_f32 v75, v67, v67
    v_mul_f32 v75, 0x3d372713, v75
    v_fma_f32 v75, v75, v67, v67
    v_mul_f32 v75, 0xc0135761, v75
    v_exp_f32 v75, v75
    s_nop 0
    v_add_f32 v75, 1.0, v75
    v_rcp_f32 v75, v75
    s_nop 0
    v_mul_f32 v67, v67, v75
    v_cvt_pk_bf16_f32 v67, v67, v67
    v_and_b32 v67, 0xffff0000, v67
    v_mul_f32 v67, v67, v71
    v_cvt_pk_bf16_f32 v32, v64, v65
    v_cvt_pk_bf16_f32 v34, v66, v67
    ds_write_b16 v9, v32 offset:4224
    ds_write_b16_d16_hi v9, v32 offset:4368
    ds_write_b16 v9, v34 offset:4512
    ds_write_b16_d16_hi v9, v34 offset:4656
    s_waitcnt lgkmcnt(0)
L_hend:
    s_mov_b64 exec, -1
    s_cmp_lg_u32 s79, 7
    s_cbranch_scc1 L_noprobe
    s_cmp_ge_u32 s73, 28
    s_cbranch_scc1 L_noprobe
    s_and_b32 s67, s73, 0xfc
    s_lshl_b32 s67, s67, 3
    s_and_b32 s65, s73, 2
    s_add_u32 s67, s67, s65
    s_and_b32 s65, s73, 3
    s_add_u32 s67, s67, s65
    s_lshl_b32 s67, s67, 12
    s_add_u32 s67, s67, 1179648
    s_mov_b32 s70, 0
    s_mov_b32 s62, 5
L_pr:
    s_mov_b32 s40, s61
    s_mov_b32 s41, s61
    s_mov_b32 s42, s61
    s_mov_b32 s43, s61
    s_mov_b32 s44, s61
    s_mov_b32 s45, s61
    s_mov_b32 s46, s61
    s_mov_b32 s47, s61
    s_add_u32 s48, s26, s67
    s_addc_u32 s49, s27, 0
    s_load_dword s40, s[48:49], 0
    s_load_dword s44, s[48:49], 8192
    s_load_dword s45, s[48:49], 8320
    s_load_dword s41, s[48:49], 128
    s_load_dword s46, s[48:49], 8448
    s_load_dword s42, s[48:49], 256
    s_load_dword s43, s[48:49], 384
    s_load_dword s47, s[48:49], 8576
    s_waitcnt lgkmcnt(4)
    s_cmp_lg_u32 s40, s61
    s_addc_u32 s70, s70, 0
    s_cmp_lg_u32 s44, s61
    s_subb_u32 s70, s70, 0
    s_cmp_lg_u32 s45, s61
    s_subb_u32 s70, s70, 0
    s_cmp_lg_u32 s41, s61
    s_addc_u32 s70, s70, 0
    s_cmp_lg_u32 s46, s61
    s_subb_u32 s70, s70, 0
    s_cmp_lg_u32 s42, s61
    s_addc_u32 s70, s70, 0
    s_cmp_lg_u32 s43, s61
    s_addc_u32 s70, s70, 0
    s_cmp_lg_u32 s47, s61
    s_subb_u32 s70, s70, 0
    s_waitcnt lgkmcnt(0)
    s_add_u32 s67, s67, 512
    s_sub_u32 s62, s62, 1
    s_cbranch_scc0 L_pr
    s_getreg_b32 s71, hwreg(HW_REG_XCC_ID, 2, 1)
    s_sub_u32 s65, 0, s70
    s_cmp_lg_u32 s71, 0
    s_cselect_b32 s70, s65, s70
    s_atomic_add s70, s[24:25], 48 glc
    s_waitcnt lgkmcnt(0)
    v_mov_b32 v7, 0
    s_mov_b32 s62, 4000
    s_nop 0
L_pw:
    ds_read_b32 v40, v7 offset:4112
    s_waitcnt lgkmcnt(0)
    v_readfirstlane_b32 s65, v40
    s_nop 0
    s_cmp_ge_u32 s65, 20
    s_nop 1
    s_cbranch_scc1 L_pv
    s_sleep 4
    s_sub_u32 s62, s62, 1
    s_cbranch_scc0 L_pw
L_pv:
    s_mov_b32 s70, 0
    s_atomic_add s70, s[24:25], 48 glc
    s_waitcnt lgkmcnt(0)
    s_lshr_b32 s70, s70, 31
    s_xor_b32 s70, s70, s71
    s_lshl_b32 s70, s70, 13
    v_mov_b32 v40, s70
    ds_write_b32 v7, v40 offset:4104
    s_waitcnt lgkmcnt(0)
L_noprobe:
    s_cmp_lg_u32 s69, 0
    s_cbranch_scc1 L_gend
    s_cmp_ge_u32 s35, 9
    s_cbranch_scc1 L_gend
    v_lshlrev_b32 v6, 2, v4
    v_lshl_add_u32 v6, v5, 7, v6
    v_mov_b32 v7, 0
    s_mov_b32 s62, 4000
    s_mul_i32 s70, s35, 2
    s_add_u32 s70, s70, 6
    s_lshl_b32 s66, s35, 2
L_gw:
    ds_read_b32 v40, v7 offset:4112
    s_waitcnt lgkmcnt(0)
    v_readfirstlane_b32 s65, v40
    s_nop 0
    s_cmp_ge_u32 s65, s70
    s_nop 1
    s_cbranch_scc1 L_gr
    s_sleep 4
    s_sub_u32 s62, s62, 1
    s_cbranch_scc0 L_gw
L_gr:
    s_lshl_b32 s70, s70, 6
    s_add_u32 s70, s70, 16
    s_mov_b32 s62, 3
L_gp:
    buffer_load_dword v40, v6, s[36:39], s34 offen sc1
    s_waitcnt vmcnt(0)
    v_add_u32_dpp v40, v40, v40 row_ror:8 row_mask:0xf bank_mask:0xf
    s_nop 1
    v_add_u32_dpp v40, v40, v40 row_ror:4 row_mask:0xf bank_mask:0xf
    s_nop 1
    v_add_u32_dpp v40, v40, v40 row_ror:2 row_mask:0xf bank_mask:0xf
    s_nop 1
    v_add_u32_dpp v40, v40, v40 row_ror:1 row_mask:0xf bank_mask:0xf
    s_nop 1
    v_add_u32_dpp v40, v40, v40 row_bcast:15 row_mask:0xa bank_mask:0xf
    s_nop 1
    v_add_u32_dpp v40, v40, v40 row_bcast:31 row_mask:0xc bank_mask:0xf
    s_nop 0
    v_readlane_b32 s71, v40, 63
    s_nop 0
    s_cmp_ge_u32 s71, s70
    s_nop 1
    s_cbranch_scc1 L_ga
    s_sub_u32 s62, s62, 1
    s_cbranch_scc0 L_gp
L_ga:
    s_mov_b32 s71, 1
    s_atomic_add s71, s[24:25], s66 glc
    s_waitcnt lgkmcnt(0)
    s_sub_u32 s71, s71, 8
    s_mul_i32 s71, s71, 6
    s_ashr_i32 s71, s71, 2
    v_mov_b32 v42, s71
    s_mov_b64 exec, 15
    buffer_store_dword v42, v2, s[36:39], s34 offen offset:64
    s_mov_b64 exec, -1
L_gend:
L_end:
    s_endpgm
.section .rodata,"a"
.p2align 6
.amdhsa_kernel parallel_sum__mha_block_cached__geglu_ffn__decode_kernel
  .amdhsa_next_free_vgpr 256
  .amdhsa_next_free_sgpr 102
  .amdhsa_accum_offset 256
  .amdhsa_group_segment_fixed_size 0
  .amdhsa_kernarg_size 96
  .amdhsa_user_sgpr_count 2
  .amdhsa_user_sgpr_kernarg_segment_ptr 1
  .amdhsa_system_sgpr_workgroup_id_x 1
.end_amdhsa_kernel
```
